```python
import torch

def _softmax(x, axis=-1):
    return torch.softmax(x, dim=axis)
def _gelu(x):
    return torch.nn.functional.gelu(x, approximate="tanh")
def _silu(x):
    return torch.nn.functional.silu(x)
def _sigmoid(x):
    return torch.sigmoid(x)
def _layernorm(x, axis=-1, eps=1e-5):
    m = x.mean(dim=axis, keepdim=True)
    v = x.var(dim=axis, keepdim=True, unbiased=False)
    return (x - m) / torch.sqrt(v + eps)
def _scatter_add(tgt, idx, src, axis=0):
    return tgt.clone().index_add_(axis, idx, src)
def _segment_sum(src, seg, n):
    out = torch.zeros((n,) + src.shape[1:], dtype=src.dtype)
    return out.index_add_(0, seg, src)
def _pad(x, pw):
    flat = tuple(v for pair in reversed(pw) for v in pair)
    return torch.nn.functional.pad(x, flat)

kernel_name = 'sequential_preLN__gqa_block_cached__dense_activation_silu__decode'

def setup_inputs():

    _w = (lambda a: (lambda t: t.to(torch.bfloat16) if t.is_floating_point() else t)(torch.as_tensor(a)))
    def _A_setup():
        B, Sq, D = 2, 1, 448
        Hq, Hkv, Sk, Dh = 16, 8, 32768, 256
        assert Hq % Hkv == 0, (Hq, Hkv)
        return {
            "x": _w((lambda *s: torch.randn(*s, dtype=torch.bfloat16) * 0.1)(B, Sq, D)),
            "k_cache": _w((lambda *s: torch.randn(*s, dtype=torch.bfloat16) * 1.6)(B, Hkv, Sk, Dh)),
            "v_cache": _w((lambda *s: torch.randn(*s, dtype=torch.bfloat16) * 1.6)(B, Hkv, Sk, Dh)),
            "wq": _w((lambda *s: torch.randn(*s, dtype=torch.bfloat16) * 1.6)(D, Hq * Dh) * (D ** -0.5)),
            "wo": _w((lambda *s: torch.randn(*s, dtype=torch.bfloat16) * 1.6)(Hq * Dh, D) * ((Hq * Dh) ** -0.5)),
        }
    _A_in = _A_setup()

    def _B_setup():
        B, S, D, F = 2, 1, 448, 1792
        return {
            "x": _w((lambda *s: torch.randn(*s, dtype=torch.bfloat16) * 0.1)(B, S, D)),
            "w1": _w((lambda *s: torch.randn(*s, dtype=torch.bfloat16) * 3.2)(D, F) * (D ** -0.5)),
            "w2": _w((lambda *s: torch.randn(*s, dtype=torch.bfloat16) * 3.2)(F, D) * (F ** -0.5)),
        }
    _B_in = _B_setup()

    return {
        "A_x": _A_in["x"],
        "A_k_cache": _A_in["k_cache"],
        "A_v_cache": _A_in["v_cache"],
        "A_wq": _A_in["wq"],
        "A_wo": _A_in["wo"],
        "B_x": _B_in["x"],
        "B_w1": _B_in["w1"],
        "B_w2": _B_in["w2"],
    }

def reference(A_x, A_k_cache, A_v_cache, A_wq, A_wo, B_x, B_w1, B_w2):
    def _A_ref(x, k_cache, v_cache, wq, wo):
        B, Sq, D = x.shape
        Hq, Dh = 16, 256
        Hkv = k_cache.shape[1]
        rep = Hq // Hkv
        q = (lambda x, *d: x.permute(*d))((x @ wq).reshape(B, Sq, Hq, Dh), 0, 2, 1, 3)
        k = (lambda x, n, axis: torch.repeat_interleave(x, n, dim=axis))(k_cache, rep, axis=1)
        v = (lambda x, n, axis: torch.repeat_interleave(x, n, dim=axis))(v_cache, rep, axis=1)
        scores = torch.einsum("bhqd,bhkd->bhqk", q, k) * (Dh ** -0.5)
        p = _softmax(scores, axis=-1)
        o = torch.einsum("bhqk,bhkd->bhqd", p, v)
        return (lambda x, *d: x.permute(*d))(o, 0, 2, 1, 3).reshape(B, Sq, Hq * Dh) @ wo

    def _B_ref(x, w1, w2):
        h = torch.einsum("bsd,df->bsf", x, w1)
        h = _silu(h)
        out = torch.einsum("bsf,fd->bsd", h, w2)
        return out

    x = A_x
    h = x + _A_ref(_layernorm(x, axis=-1), A_k_cache, A_v_cache, A_wq, A_wo)
    h2 = h + _B_ref(_layernorm(h, axis=-1), B_w1, B_w2)
    return h2
```

```asm
; @launch grid=(256,1,1) block=(320,1,1) lds=75776
.amdgcn_target "amdgcn-amd-amdhsa--gfx950"
.text
.globl sequential_preLN__gqa_block_cached__dense_activation_silu__decode_kernel
.p2align 8
.type sequential_preLN__gqa_block_cached__dense_activation_silu__decode_kernel,@function
sequential_preLN__gqa_block_cached__dense_activation_silu__decode_kernel:
    s_cmp_ge_u32 s2, 256
    s_cbranch_scc1 L_end
    s_load_dwordx2 s[4:5], s[0:1], 8
    s_load_dwordx2 s[24:25], s[0:1], 0
    s_load_dwordx2 s[12:13], s[0:1], 80
    s_load_dwordx4 s[28:31], s[0:1], 24
    s_load_dwordx2 s[8:9], s[0:1], 16
    s_load_dwordx4 s[32:35], s[0:1], 48
    s_load_dwordx2 s[40:41], s[0:1], 64
    s_getpc_b64 s[96:97]
L_pc:
    v_lshlrev_b32 v178, 7, v0
    v_min_u32 v178, L_codeend - L_pc - 4, v178
    global_load_dword v177, v178, s[96:97]
    v_lshrrev_b32 v10, 6, v0
    v_and_b32 v1, 63, v0
    v_readfirstlane_b32 s3, v10
    s_lshr_b32 s65, s2, 4
    s_and_b32 s66, s2, 15
    s_xor_b32 s82, s2, 2
    s_bfe_u32 s83, s2, 0x10003
    s_and_b32 s67, s82, 1
    s_lshl1_add_u32 s67, s67, s83
    s_lshl2_add_u32 s67, s65, s67
    s_bitcmp1_b32 s82, 1
    s_cselect_b32 s68, 56, 0
    s_cselect_b32 s84, 64, 56
    s_cmp_lt_u32 s67, 56
    s_cselect_b32 s68, s68, s84
    s_add_u32 s67, s67, s68
    s_add_u32 s67, s67, 128
    s_and_b32 s68, s82, 3
    s_lshl1_add_u32 s68, s68, s83
    s_lshl3_add_u32 s68, s65, s68
    s_bitcmp1_b32 s82, 2
    s_cselect_b32 s2, s68, s67
    v_bfe_u32 v10, v1, 3, 2
    v_lshlrev_b32 v10, 9, v10
    v_and_b32 v11, 7, v1
    v_lshl_add_u32 v2, v11, 4, v10
    v_lshrrev_b32 v10, 5, v1
    v_lshl_add_u32 v2, v10, 7, v2
    v_lshlrev_b32 v18, 4, v1
    s_lshl_b32 s69, s65, 24
    s_and_b32 s67, s66, 3
    s_lshl2_add_u32 s67, s83, s67
    s_and_b32 s49, s65, 7
    s_lshl_b32 s49, s49, 18
    s_lshl_b32 s67, s67, 21
    s_add_u32 s43, s69, s67
    s_add_u32 s49, s49, s43
    s_bfe_u32 s67, s66, 0x10002
    s_mul_i32 s67, s67, 16384
    s_mul_i32 s68, s3, 4096
    s_add_u32 s67, s67, s68
    s_add_u32 s60, s49, s67
    s_mov_b32 s52, s60
    s_add_u32 s53, s52, 32768
    s_add_u32 s54, s52, 65536
    s_add_u32 s55, s52, 98304
    s_mov_b32 s6, 268435456
    s_mov_b32 s7, 0x00020000
    s_mov_b32 s10, 268435456
    s_mov_b32 s11, 0x00020000
    s_mov_b32 s14, 2097152
    s_mov_b32 s15, 0x00020000
    s_mov_b32 s26, 1792
    s_mov_b32 s27, 0x00020000
    s_mov_b32 s19, 0x00020000
    s_sub_u32 s64, s2, 128
    s_sub_u32 s67, s2, 184
    s_cmp_lt_u32 s64, 56
    s_cselect_b32 s64, s64, s67
    s_cselect_b32 s67, s2, 0
    s_cmp_ge_u32 s2, 240
    s_cselect_b32 s67, s2, s67
    s_cmp_eq_u32 s67, 0
    s_cselect_b32 s64, 64, s64
    s_cmp_eq_u32 s3, 4
    s_cbranch_scc1 L_helper
    s_cmp_lt_u32 s64, 64
    s_cbranch_scc1 L_sprod
    s_waitcnt lgkmcnt(0)
    buffer_load_dwordx4 v[112:115], v2, s[4:7], s52 offen offset:0 nt
    buffer_load_dwordx4 v[116:119], v2, s[4:7], s52 offen offset:256 nt
    buffer_load_dwordx4 v[120:123], v2, s[4:7], s52 offen offset:2048 nt
    buffer_load_dwordx4 v[124:127], v2, s[4:7], s52 offen offset:2304 nt
    buffer_load_dwordx4 v[128:131], v2, s[4:7], s53 offen offset:0 nt
L_sjoin:
    s_load_dword s71, s[12:13], 0
    v_lshrrev_b32 v10, 4, v1
    v_lshlrev_b32 v10, 10, v10
    v_and_b32 v11, 15, v1
    v_lshl_add_u32 v3, v11, 4, v10
    s_and_b32 s67, s66, 4
    s_add_u32 s67, s67, s3
    s_lshl_b32 s67, s67, 12
    s_add_u32 s61, s49, s67
    s_add_u32 s61, s61, 1835008
    s_and_b32 s61, s61, 0x1fffff
    s_add_u32 s61, s61, s43
    s_add_u32 s62, s61, 32768
    s_lshl_b32 s67, s3, 12
    s_add_u32 s69, s69, s67
    s_add_u32 s67, s65, 7
    s_and_b32 s67, s67, 7
    s_lshl_b32 s67, s67, 18
    s_add_u32 s69, s69, s67
    s_add_u32 s69, s69, 65536
    s_sub_u32 s42, s2, 184
    s_mov_b64 s[20:21], s[32:33]
    s_mov_b32 s22, 1605632
    s_mov_b32 s23, 0x00020000
    s_cmp_lt_u32 s2, 128
    s_cselect_b32 s16, s30, s34
    s_cselect_b32 s17, s31, s35
    s_cselect_b32 s18, 3670016, s22
    s_cselect_b32 s90, s2, s42
    s_cselect_b32 s93, 1, 0
    s_cmp_lt_u32 s42, 56
    s_cselect_b32 s93, 2, s93
    s_lshl_b32 s92, s42, 6
    s_mul_i32 s67, s3, 401408
    s_add_u32 s92, s92, s67
    s_mul_i32 s90, s90, 28672
    s_mul_i32 s67, s3, 7168
    s_add_u32 s90, s90, s67
    s_add_u32 s91, s90, 4096
    v_lshrrev_b32 v10, 2, v1
    v_mul_u32_u24 v10, 3584, v10
    v_and_b32 v11, 3, v1
    v_lshl_add_u32 v19, v11, 4, v10
    s_mov_b32 s72, 0xcccccccc
    s_mov_b32 s73, 0xcccccccc
    s_mov_b32 s74, 0xaaaaaaaa
    s_mov_b32 s75, 0xaaaaaaaa
    s_mov_b32 s76, 0xff00ff00
    s_mov_b32 s77, 0xff00ff00
    s_mov_b32 s70, 0x3db8aa3b
    s_mov_b32 s89, 0
    v_mov_b32 v5, 0xff800000
    v_mov_b32 v6, 0
    v_mov_b32 v7, 0
    v_mov_b32 v56, 0
    v_mov_b32 v57, 0
    v_mov_b32 v58, 0
    v_mov_b32 v59, 0
    v_mov_b32 v60, 0
    v_mov_b32 v61, 0
    v_mov_b32 v62, 0
    v_mov_b32 v63, 0
    v_and_b32 v10, 1, v1
    v_lshlrev_b32 v10, 4, v10
    v_mov_b32 v11, 0xffff
    v_lshlrev_b32 v11, v10, v11
    v_bfe_u32 v10, v1, 1, 2
    v_cmp_eq_u32 vcc, 0, v10
    s_nop 1
    v_cndmask_b32 v52, 0, v11, vcc
    v_cmp_eq_u32 vcc, 1, v10
    s_nop 1
    v_cndmask_b32 v53, 0, v11, vcc
    v_cmp_eq_u32 vcc, 2, v10
    s_nop 1
    v_cndmask_b32 v54, 0, v11, vcc
    v_cmp_eq_u32 vcc, 3, v10
    s_nop 1
    v_cndmask_b32 v55, 0, v11, vcc
    s_lshl_b32 s67, s3, 12
    s_add_u32 s67, s67, 2048
    v_lshl_add_u32 v4, v1, 2, s67
    s_lshl_b32 s67, s65, 2
    s_add_u32 s67, s67, s3
    s_lshl_b32 s67, s67, 8
    s_add_u32 s67, s67, 4096
    s_add_u32 s86, s12, s67
    s_addc_u32 s87, s13, 0
    v_lshrrev_b32 v10, 4, v1
    v_bfe_u32 v11, v1, 2, 2
    v_lshl_add_u32 v26, v10, 3, v11
    v_mul_u32_u24 v26, 896, v26
    v_lshl_add_u32 v27, v10, 3, v11
    v_and_b32 v11, 3, v1
    v_lshlrev_b32 v11, 3, v11
    v_lshl_add_u32 v27, v27, 6, v11
    s_lshl_b32 s67, s3, 8
    v_add3_u32 v26, v26, v11, s67
    s_and_b32 s67, s3, 1
    s_lshl_b32 s82, s67, 5
    s_lshr_b32 s68, s3, 1
    s_mul_i32 s68, s68, 14336
    s_add_u32 s68, s82, s68
    v_add_u32 v27, s68, v27
    v_mov_b32 v36, 0
    s_mov_b32 s28, 0x7060500
    v_mov_b32 v37, 0
    s_mov_b32 s29, 0x7060501
    v_mov_b32 v38, 0
    s_mov_b32 s30, 0x7060502
    v_mov_b32 v39, 0
    s_mov_b32 s31, 0x7060503
    ds_write_b128 v36, v[36:39] offset:64
    s_mov_b32 s32, 0x0c0c0400
    s_mov_b32 s33, 0x04000c0c
    v_mov_b32 v25, s82
    s_lshl_b32 s83, s3, 12
    s_add_u32 s83, s83, 2048
    v_add_u32 v21, s83, v18
    s_lshl_b32 s83, s3, 2
    v_lshl_add_u32 v22, v1, 3, s83
    v_lshrrev_b32 v10, 5, v1
    v_bfe_u32 v11, v1, 3, 2
    v_lshlrev_b32 v10, 10, v10
    v_lshl_add_u32 v10, v11, 8, v10
    v_and_b32 v11, 7, v1
    v_lshl_add_u32 v10, v11, 4, v10
    s_lshl_b32 s83, s67, 7
    v_add_u32 v23, s83, v10
    v_lshrrev_b32 v10, 4, v1
    v_lshlrev_b32 v10, 14, v10
    v_lshl_add_u32 v24, v11, 4, v10
    v_bfe_u32 v10, v1, 3, 1
    v_lshl_add_u32 v24, v10, 12, v24
    v_lshlrev_b32 v28, 8, v1
    s_and_b32 s34, s65, 7
    s_lshl_b32 s34, s34, 1
    s_add_u32 s34, s34, s67
    s_lshl_b32 s34, s34, 16
    s_lshr_b32 s83, s65, 3
    s_lshl_b32 s83, s83, 11
    s_add_u32 s34, s34, s83
    s_lshl_b32 s83, s66, 7
    s_add_u32 s34, s34, s83
    s_add_u32 s34, s34, 262144
    s_lshr_b32 s35, s65, 2
    s_lshl_b32 s35, s35, 3
    s_and_b32 s83, s65, 3
    s_add_u32 s35, s35, s83
    s_lshl_b32 s35, s35, 5
    s_add_u32 s35, s35, s66
    s_lshl_b32 s35, s35, 2
    s_add_u32 s35, s35, s3
    s_lshl_b32 s35, s35, 4
    s_add_u32 s35, s35, 1310720
    s_add_u32 s56, s52, 131072
    s_add_u32 s57, s56, 32768
    s_add_u32 s58, s56, 65536
    s_add_u32 s59, s56, 98304
    v_bfe_u32 v10, v1, 4, 1
    v_lshlrev_b32 v10, 9, v10
    v_bfe_u32 v11, v1, 3, 1
    v_lshl_add_u32 v10, v11, 6, v10
    v_and_b32 v11, 3, v1
    v_lshl_add_u32 v10, v11, 4, v10
    v_lshrrev_b32 v11, 5, v1
    v_lshl_add_u32 v10, v11, 7, v10
    s_waitcnt vmcnt(4)
    buffer_load_dwordx4 v[132:135], v2, s[4:7], s53 offen offset:256 nt
    s_waitcnt vmcnt(4)
    buffer_load_dwordx4 v[136:139], v2, s[4:7], s53 offen offset:2048 nt
    s_waitcnt vmcnt(4)
    buffer_load_dwordx4 v[140:143], v2, s[4:7], s53 offen offset:2304 nt
    s_waitcnt vmcnt(4)
    buffer_load_dwordx4 v[144:147], v2, s[4:7], s54 offen offset:0 nt
    s_waitcnt vmcnt(4)
    buffer_load_dwordx4 v[148:151], v2, s[4:7], s54 offen offset:256 nt
    s_waitcnt vmcnt(4)
    buffer_load_dwordx4 v[152:155], v2, s[4:7], s54 offen offset:2048 nt
    s_waitcnt vmcnt(4)
    buffer_load_dwordx4 v[156:159], v2, s[4:7], s54 offen offset:2304 nt
    s_waitcnt vmcnt(4)
    buffer_load_dwordx4 v[160:163], v2, s[4:7], s55 offen offset:0 nt
    s_waitcnt vmcnt(4)
    buffer_load_dwordx4 v[164:167], v2, s[4:7], s55 offen offset:256 nt
    s_waitcnt vmcnt(4)
    buffer_load_dwordx4 v[168:171], v2, s[4:7], s55 offen offset:2048 nt
    s_waitcnt vmcnt(4)
    buffer_load_dwordx4 v[172:175], v2, s[4:7], s55 offen offset:2304 nt
    s_waitcnt vmcnt(4)
    buffer_load_dwordx4 a[0:3], v2, s[4:7], s56 offen offset:0 nt
    s_waitcnt vmcnt(4)
    buffer_load_dwordx4 a[4:7], v2, s[4:7], s56 offen offset:256 nt
    s_waitcnt vmcnt(4)
    buffer_load_dwordx4 a[8:11], v2, s[4:7], s56 offen offset:2048 nt
    s_waitcnt vmcnt(4)
    buffer_load_dwordx4 a[12:15], v2, s[4:7], s56 offen offset:2304 nt
    s_waitcnt vmcnt(4)
    buffer_load_dwordx4 a[16:19], v2, s[4:7], s57 offen offset:0 nt
    s_waitcnt vmcnt(4)
    buffer_load_dwordx4 a[20:23], v2, s[4:7], s57 offen offset:256 nt
    s_waitcnt vmcnt(4)
    buffer_load_dwordx4 a[24:27], v2, s[4:7], s57 offen offset:2048 nt
    s_waitcnt vmcnt(4)
    s_mul_i32 s67, s3, 7168
    s_cmp_eq_u32 s93, 0
    s_cbranch_scc1 L_nodma
    s_add_u32 m0, s67, 18432
    s_nop 0
    s_waitcnt vmcnt(4)
    buffer_load_dwordx4 v18, s[16:19], s90 offen offset:0 nt lds
    s_waitcnt vmcnt(4)
    buffer_load_dwordx4 v18, s[16:19], s90 offen offset:1024 nt lds
    s_waitcnt vmcnt(4)
    buffer_load_dwordx4 v18, s[16:19], s90 offen offset:2048 nt lds
    s_waitcnt vmcnt(4)
    buffer_load_dwordx4 v18, s[16:19], s90 offen offset:3072 nt lds
    s_add_u32 m0, s67, 22528
    s_nop 0
    s_waitcnt vmcnt(4)
    buffer_load_dwordx4 v18, s[16:19], s91 offen offset:0 nt lds
    s_waitcnt vmcnt(4)
    buffer_load_dwordx4 v18, s[16:19], s91 offen offset:1024 nt lds
    s_waitcnt vmcnt(4)
    buffer_load_dwordx4 v18, s[16:19], s91 offen offset:2048 nt lds
L_nodma:
    s_barrier
    buffer_load_dwordx4 a[28:31], v2, s[4:7], s57 offen offset:2304 nt
    s_waitcnt vmcnt(4)
    buffer_load_dwordx4 a[32:35], v2, s[4:7], s58 offen offset:0 nt
    s_waitcnt vmcnt(4)
    buffer_load_dwordx4 a[36:39], v2, s[4:7], s58 offen offset:256 nt
    s_waitcnt vmcnt(4)
    buffer_load_dwordx4 a[40:43], v2, s[4:7], s58 offen offset:2048 nt
    s_waitcnt vmcnt(4)
    buffer_load_dwordx4 a[44:47], v2, s[4:7], s58 offen offset:2304 nt
    s_waitcnt vmcnt(4)
    buffer_load_dwordx4 a[48:51], v2, s[4:7], s59 offen offset:0 nt
    s_waitcnt vmcnt(4)
    buffer_load_dwordx4 a[52:55], v2, s[4:7], s59 offen offset:256 nt
    s_waitcnt vmcnt(4)
    buffer_load_dwordx4 a[56:59], v2, s[4:7], s59 offen offset:2048 nt
    s_waitcnt vmcnt(4)
    buffer_load_dwordx4 a[60:63], v2, s[4:7], s59 offen offset:2304 nt
    s_waitcnt lgkmcnt(0)
    s_barrier
    v_mov_b32 v12, 0
    ds_read_b32 v12, v12 offset:80
    ds_read_b128 v[64:67], v10 offset:1024
    ds_read_b128 v[68:71], v10 offset:1280
    v_bfe_u32 v11, v1, 2, 1
    v_cmp_eq_u32 vcc, 0, v11
    s_lshr_b32 s67, s66, 2
    s_xor_b32 s67, s67, s66
    s_lshl_b32 s82, s3, 14
    s_add_u32 s82, s82, s49
    s_waitcnt lgkmcnt(2)
    v_readfirstlane_b32 s68, v12
    s_mul_i32 s71, s71, 1664525
    s_add_u32 s71, s71, 1013904223
    s_xor_b32 s83, s67, s68
    s_and_b32 s83, s83, 1
    s_lshl_b32 s83, s83, 13
    s_add_u32 s83, s83, s82
    s_and_b32 s48, s68, 8
    s_cselect_b32 s52, s83, s60
    s_cselect_b32 s82, 1, 8
    s_cselect_b32 s83, 16, 16
    s_cselect_b32 s84, 17, 24
    s_lshl_b32 s44, s82, 12
    s_lshl_b32 s45, s83, 12
    s_lshl_b32 s46, s84, 12
    s_add_u32 s47, s52, 131072
    s_add_u32 s52, s52, 262144
    s_and_b32 s52, s52, 0x1fffff
    s_add_u32 s52, s52, s43
    s_add_u32 s53, s52, s44
    s_add_u32 s54, s52, s45
    s_add_u32 s55, s52, s46
    s_bfe_u32 s50, s68, 0x10002
    s_lshl_b32 s50, s50, 13
    s_sub_u32 s51, 8192, s50
    s_add_u32 s34, s34, s51
    s_add_u32 s35, s35, s51
    v_mov_b32 v20, s71
    s_waitcnt lgkmcnt(0)
    v_cndmask_b32 v72, v64, 0, vcc
    v_cndmask_b32 v73, v65, 0, vcc
    v_cndmask_b32 v74, v66, 0, vcc
    v_cndmask_b32 v75, v67, 0, vcc
    v_cndmask_b32 v76, v68, 0, vcc
    v_cndmask_b32 v77, v69, 0, vcc
    v_cndmask_b32 v78, v70, 0, vcc
    v_cndmask_b32 v79, v71, 0, vcc
    v_cndmask_b32 v64, 0, v64, vcc
    v_cndmask_b32 v65, 0, v65, vcc
    v_cndmask_b32 v66, 0, v66, vcc
    v_cndmask_b32 v67, 0, v67, vcc
    v_cndmask_b32 v68, 0, v68, vcc
    v_cndmask_b32 v69, 0, v69, vcc
    v_cndmask_b32 v70, 0, v70, vcc
    v_cndmask_b32 v71, 0, v71, vcc
    s_nop 1
    s_waitcnt vmcnt(4)
    v_mfma_f32_32x32x16_bf16 v[80:95], v[64:67], v[112:115], 0
    buffer_load_dwordx4 v[112:115], v2, s[4:7], s52 offen offset:0 nt
    s_waitcnt vmcnt(5)
    v_mfma_f32_32x32x16_bf16 v[80:95], v[68:71], v[116:119], v[80:95]
    buffer_load_dwordx4 v[116:119], v2, s[4:7], s52 offen offset:256 nt
    s_waitcnt vmcnt(4)
    v_mfma_f32_32x32x16_bf16 v[80:95], v[72:75], v[120:123], v[80:95]
    buffer_load_dwordx4 v[120:123], v2, s[4:7], s52 offen offset:2048 nt
    s_waitcnt vmcnt(5)
    v_mfma_f32_32x32x16_bf16 v[80:95], v[76:79], v[124:127], v[80:95]
    buffer_load_dwordx4 v[124:127], v2, s[4:7], s52 offen offset:2304 nt
    s_waitcnt vmcnt(4)
    v_mfma_f32_32x32x16_bf16 v[96:111], v[64:67], v[128:131], 0
    buffer_load_dwordx4 v[128:131], v2, s[4:7], s53 offen offset:0 nt
    s_waitcnt vmcnt(5)
    v_mfma_f32_32x32x16_bf16 v[96:111], v[68:71], v[132:135], v[96:111]
    buffer_load_dwordx4 v[132:135], v2, s[4:7], s53 offen offset:256 nt
    s_waitcnt vmcnt(4)
    v_mfma_f32_32x32x16_bf16 v[96:111], v[72:75], v[136:139], v[96:111]
    buffer_load_dwordx4 v[136:139], v2, s[4:7], s53 offen offset:2048 nt
    s_waitcnt vmcnt(5)
    v_mfma_f32_32x32x16_bf16 v[96:111], v[76:79], v[140:143], v[96:111]
    buffer_load_dwordx4 v[140:143], v2, s[4:7], s53 offen offset:2304 nt
    v_add_f32_dpp v36, v84, v80 row_shl:4 row_mask:0xf bank_mask:0x5
    v_add_f32_dpp v36, v88, v92 row_shr:4 row_mask:0xf bank_mask:0xa
    v_add_f32_dpp v37, v85, v81 row_shl:4 row_mask:0xf bank_mask:0x5
    v_add_f32_dpp v37, v89, v93 row_shr:4 row_mask:0xf bank_mask:0xa
    v_add_f32_dpp v38, v86, v82 row_shl:4 row_mask:0xf bank_mask:0x5
    v_add_f32_dpp v38, v90, v94 row_shr:4 row_mask:0xf bank_mask:0xa
    v_add_f32_dpp v39, v87, v83 row_shl:4 row_mask:0xf bank_mask:0x5
    v_add_f32_dpp v39, v91, v95 row_shr:4 row_mask:0xf bank_mask:0xa
    s_waitcnt vmcnt(4)
    v_mfma_f32_32x32x16_bf16 v[80:95], v[64:67], v[144:147], 0
    buffer_load_dwordx4 v[144:147], v2, s[4:7], s54 offen offset:0 nt
    s_waitcnt vmcnt(5)
    v_mfma_f32_32x32x16_bf16 v[80:95], v[68:71], v[148:151], v[80:95]
    buffer_load_dwordx4 v[148:151], v2, s[4:7], s54 offen offset:256 nt
    s_waitcnt vmcnt(4)
    v_mfma_f32_32x32x16_bf16 v[80:95], v[72:75], v[152:155], v[80:95]
    buffer_load_dwordx4 v[152:155], v2, s[4:7], s54 offen offset:2048 nt
    s_waitcnt vmcnt(5)
    v_mfma_f32_32x32x16_bf16 v[80:95], v[76:79], v[156:159], v[80:95]
    buffer_load_dwordx4 v[156:159], v2, s[4:7], s54 offen offset:2304 nt
    v_add_f32_dpp v40, v100, v96 row_shl:4 row_mask:0xf bank_mask:0x5
    v_add_f32_dpp v40, v104, v108 row_shr:4 row_mask:0xf bank_mask:0xa
    v_add_f32_dpp v41, v101, v97 row_shl:4 row_mask:0xf bank_mask:0x5
    v_add_f32_dpp v41, v105, v109 row_shr:4 row_mask:0xf bank_mask:0xa
    v_add_f32_dpp v42, v102, v98 row_shl:4 row_mask:0xf bank_mask:0x5
    v_add_f32_dpp v42, v106, v110 row_shr:4 row_mask:0xf bank_mask:0xa
    v_add_f32_dpp v43, v103, v99 row_shl:4 row_mask:0xf bank_mask:0x5
    v_add_f32_dpp v43, v107, v111 row_shr:4 row_mask:0xf bank_mask:0xa
    s_nop 1
    v_add_f32_dpp v10, v38, v36 quad_perm:[2,3,0,1] row_mask:0xf bank_mask:0xf
    v_add_f32_dpp v11, v40, v42 quad_perm:[2,3,0,1] row_mask:0xf bank_mask:0xf
    v_cndmask_b32 v32, v10, v11, s[72:73]
    v_add_f32_dpp v10, v39, v37 quad_perm:[2,3,0,1] row_mask:0xf bank_mask:0xf
    v_add_f32_dpp v11, v41, v43 quad_perm:[2,3,0,1] row_mask:0xf bank_mask:0xf
    v_cndmask_b32 v33, v10, v11, s[72:73]
    s_waitcnt vmcnt(4)
    v_mfma_f32_32x32x16_bf16 v[96:111], v[64:67], v[160:163], 0
    buffer_load_dwordx4 v[160:163], v2, s[4:7], s55 offen offset:0 nt
    s_waitcnt vmcnt(6)
    v_mfma_f32_32x32x16_bf16 v[96:111], v[68:71], v[164:167], v[96:111]
    buffer_load_dwordx4 v[164:167], v2, s[4:7], s55 offen offset:256 nt
    s_waitcnt vmcnt(6)
    v_mfma_f32_32x32x16_bf16 v[96:111], v[72:75], v[168:171], v[96:111]
    buffer_load_dwordx4 v[168:171], v2, s[4:7], s55 offen offset:2048 nt
    s_waitcnt vmcnt(8)
    v_mfma_f32_32x32x16_bf16 v[96:111], v[76:79], v[172:175], v[96:111]
    buffer_load_dwordx4 v[172:175], v2, s[4:7], s55 offen offset:2304 nt
    v_add_f32_dpp v36, v84, v80 row_shl:4 row_mask:0xf bank_mask:0x5
    v_add_f32_dpp v36, v88, v92 row_shr:4 row_mask:0xf bank_mask:0xa
    v_add_f32_dpp v37, v85, v81 row_shl:4 row_mask:0xf bank_mask:0x5
    v_add_f32_dpp v37, v89, v93 row_shr:4 row_mask:0xf bank_mask:0xa
    v_add_f32_dpp v38, v86, v82 row_shl:4 row_mask:0xf bank_mask:0x5
    v_add_f32_dpp v38, v90, v94 row_shr:4 row_mask:0xf bank_mask:0xa
    v_add_f32_dpp v39, v87, v83 row_shl:4 row_mask:0xf bank_mask:0x5
    v_add_f32_dpp v39, v91, v95 row_shr:4 row_mask:0xf bank_mask:0xa
    s_nop 3
    v_add_f32_dpp v40, v100, v96 row_shl:4 row_mask:0xf bank_mask:0x5
    v_add_f32_dpp v40, v104, v108 row_shr:4 row_mask:0xf bank_mask:0xa
    v_add_f32_dpp v41, v101, v97 row_shl:4 row_mask:0xf bank_mask:0x5
    v_add_f32_dpp v41, v105, v109 row_shr:4 row_mask:0xf bank_mask:0xa
    v_add_f32_dpp v42, v102, v98 row_shl:4 row_mask:0xf bank_mask:0x5
    v_add_f32_dpp v42, v106, v110 row_shr:4 row_mask:0xf bank_mask:0xa
    v_add_f32_dpp v43, v103, v99 row_shl:4 row_mask:0xf bank_mask:0x5
    v_add_f32_dpp v43, v107, v111 row_shr:4 row_mask:0xf bank_mask:0xa
    s_nop 1
    v_add_f32_dpp v10, v38, v36 quad_perm:[2,3,0,1] row_mask:0xf bank_mask:0xf
    v_add_f32_dpp v11, v40, v42 quad_perm:[2,3,0,1] row_mask:0xf bank_mask:0xf
    v_cndmask_b32 v34, v10, v11, s[72:73]
    v_add_f32_dpp v10, v39, v37 quad_perm:[2,3,0,1] row_mask:0xf bank_mask:0xf
    v_add_f32_dpp v11, v41, v43 quad_perm:[2,3,0,1] row_mask:0xf bank_mask:0xf
    v_cndmask_b32 v35, v10, v11, s[72:73]
    s_nop 1
    v_add_f32_dpp v10, v33, v32 quad_perm:[1,0,3,2] row_mask:0xf bank_mask:0xf
    v_add_f32_dpp v11, v34, v35 quad_perm:[1,0,3,2] row_mask:0xf bank_mask:0xf
    v_cndmask_b32 v8, v10, v11, s[74:75]
    v_cvt_pk_bf16_f32 v8, v8, v8
    v_and_b32 v8, 0xffff0000, v8
    ds_write_b32 v4, v8
    v_max_f32 v5, v5, v8
    v_add_u32 v4, 256, v4
    s_waitcnt vmcnt(16)
    v_mfma_f32_32x32x16_bf16 v[80:95], v[64:67], a[0:3], 0
    s_waitcnt vmcnt(16)
    v_mfma_f32_32x32x16_bf16 v[80:95], v[68:71], a[4:7], v[80:95]
    s_waitcnt vmcnt(16)
    v_mfma_f32_32x32x16_bf16 v[80:95], v[72:75], a[8:11], v[80:95]
    s_waitcnt vmcnt(16)
    v_mfma_f32_32x32x16_bf16 v[80:95], v[76:79], a[12:15], v[80:95]
    s_waitcnt vmcnt(16)
    v_mfma_f32_32x32x16_bf16 v[96:111], v[64:67], a[16:19], 0
    s_waitcnt vmcnt(16)
    v_mfma_f32_32x32x16_bf16 v[96:111], v[68:71], a[20:23], v[96:111]
    s_waitcnt vmcnt(16)
    v_mfma_f32_32x32x16_bf16 v[96:111], v[72:75], a[24:27], v[96:111]
    s_waitcnt vmcnt(16)
    v_mfma_f32_32x32x16_bf16 v[96:111], v[76:79], a[28:31], v[96:111]
    s_nop 3
    v_add_f32_dpp v36, v84, v80 row_shl:4 row_mask:0xf bank_mask:0x5
    v_add_f32_dpp v36, v88, v92 row_shr:4 row_mask:0xf bank_mask:0xa
    v_add_f32_dpp v37, v85, v81 row_shl:4 row_mask:0xf bank_mask:0x5
    v_add_f32_dpp v37, v89, v93 row_shr:4 row_mask:0xf bank_mask:0xa
    v_add_f32_dpp v38, v86, v82 row_shl:4 row_mask:0xf bank_mask:0x5
    v_add_f32_dpp v38, v90, v94 row_shr:4 row_mask:0xf bank_mask:0xa
    v_add_f32_dpp v39, v87, v83 row_shl:4 row_mask:0xf bank_mask:0x5
    v_add_f32_dpp v39, v91, v95 row_shr:4 row_mask:0xf bank_mask:0xa
    s_waitcnt vmcnt(16)
    v_mfma_f32_32x32x16_bf16 v[80:95], v[64:67], a[32:35], 0
    s_waitcnt vmcnt(16)
    v_mfma_f32_32x32x16_bf16 v[80:95], v[68:71], a[36:39], v[80:95]
    s_waitcnt vmcnt(16)
    v_mfma_f32_32x32x16_bf16 v[80:95], v[72:75], a[40:43], v[80:95]
    s_waitcnt vmcnt(16)
    v_mfma_f32_32x32x16_bf16 v[80:95], v[76:79], a[44:47], v[80:95]
    s_nop 3
    v_add_f32_dpp v40, v100, v96 row_shl:4 row_mask:0xf bank_mask:0x5
    v_add_f32_dpp v40, v104, v108 row_shr:4 row_mask:0xf bank_mask:0xa
    v_add_f32_dpp v41, v101, v97 row_shl:4 row_mask:0xf bank_mask:0x5
    v_add_f32_dpp v41, v105, v109 row_shr:4 row_mask:0xf bank_mask:0xa
    v_add_f32_dpp v42, v102, v98 row_shl:4 row_mask:0xf bank_mask:0x5
    v_add_f32_dpp v42, v106, v110 row_shr:4 row_mask:0xf bank_mask:0xa
    v_add_f32_dpp v43, v103, v99 row_shl:4 row_mask:0xf bank_mask:0x5
    v_add_f32_dpp v43, v107, v111 row_shr:4 row_mask:0xf bank_mask:0xa
    s_nop 1
    v_add_f32_dpp v10, v38, v36 quad_perm:[2,3,0,1] row_mask:0xf bank_mask:0xf
    v_add_f32_dpp v11, v40, v42 quad_perm:[2,3,0,1] row_mask:0xf bank_mask:0xf
    v_cndmask_b32 v32, v10, v11, s[72:73]
    v_add_f32_dpp v10, v39, v37 quad_perm:[2,3,0,1] row_mask:0xf bank_mask:0xf
    v_add_f32_dpp v11, v41, v43 quad_perm:[2,3,0,1] row_mask:0xf bank_mask:0xf
    v_cndmask_b32 v33, v10, v11, s[72:73]
    s_waitcnt vmcnt(16)
    v_mfma_f32_32x32x16_bf16 v[96:111], v[64:67], a[48:51], 0
    s_waitcnt vmcnt(16)
    v_mfma_f32_32x32x16_bf16 v[96:111], v[68:71], a[52:55], v[96:111]
    s_waitcnt vmcnt(16)
    v_mfma_f32_32x32x16_bf16 v[96:111], v[72:75], a[56:59], v[96:111]
    s_waitcnt vmcnt(16)
    v_mfma_f32_32x32x16_bf16 v[96:111], v[76:79], a[60:63], v[96:111]
    s_nop 3
    v_add_f32_dpp v36, v84, v80 row_shl:4 row_mask:0xf bank_mask:0x5
    v_add_f32_dpp v36, v88, v92 row_shr:4 row_mask:0xf bank_mask:0xa
    v_add_f32_dpp v37, v85, v81 row_shl:4 row_mask:0xf bank_mask:0x5
    v_add_f32_dpp v37, v89, v93 row_shr:4 row_mask:0xf bank_mask:0xa
    v_add_f32_dpp v38, v86, v82 row_shl:4 row_mask:0xf bank_mask:0x5
    v_add_f32_dpp v38, v90, v94 row_shr:4 row_mask:0xf bank_mask:0xa
    v_add_f32_dpp v39, v87, v83 row_shl:4 row_mask:0xf bank_mask:0x5
    v_add_f32_dpp v39, v91, v95 row_shr:4 row_mask:0xf bank_mask:0xa
    s_nop 3
    v_add_f32_dpp v40, v100, v96 row_shl:4 row_mask:0xf bank_mask:0x5
    v_add_f32_dpp v40, v104, v108 row_shr:4 row_mask:0xf bank_mask:0xa
    v_add_f32_dpp v41, v101, v97 row_shl:4 row_mask:0xf bank_mask:0x5
    v_add_f32_dpp v41, v105, v109 row_shr:4 row_mask:0xf bank_mask:0xa
    v_add_f32_dpp v42, v102, v98 row_shl:4 row_mask:0xf bank_mask:0x5
    v_add_f32_dpp v42, v106, v110 row_shr:4 row_mask:0xf bank_mask:0xa
    v_add_f32_dpp v43, v103, v99 row_shl:4 row_mask:0xf bank_mask:0x5
    v_add_f32_dpp v43, v107, v111 row_shr:4 row_mask:0xf bank_mask:0xa
    s_nop 1
    v_add_f32_dpp v10, v38, v36 quad_perm:[2,3,0,1] row_mask:0xf bank_mask:0xf
    v_add_f32_dpp v11, v40, v42 quad_perm:[2,3,0,1] row_mask:0xf bank_mask:0xf
    v_cndmask_b32 v34, v10, v11, s[72:73]
    v_add_f32_dpp v10, v39, v37 quad_perm:[2,3,0,1] row_mask:0xf bank_mask:0xf
    v_add_f32_dpp v11, v41, v43 quad_perm:[2,3,0,1] row_mask:0xf bank_mask:0xf
    v_cndmask_b32 v35, v10, v11, s[72:73]
    s_nop 1
    v_add_f32_dpp v10, v33, v32 quad_perm:[1,0,3,2] row_mask:0xf bank_mask:0xf
    v_add_f32_dpp v11, v34, v35 quad_perm:[1,0,3,2] row_mask:0xf bank_mask:0xf
    v_cndmask_b32 v8, v10, v11, s[74:75]
    v_cvt_pk_bf16_f32 v8, v8, v8
    v_and_b32 v8, 0xffff0000, v8
    ds_write_b32 v4, v8
    v_max_f32 v5, v5, v8
    v_add_u32 v4, 256, v4
    s_mov_b32 s64, 3
L_ks:
    s_add_u32 s52, s52, 131072
    s_and_b32 s52, s52, 0x1fffff
    s_add_u32 s52, s52, s43
    s_add_u32 s53, s52, s44
    s_add_u32 s54, s52, s45
    s_add_u32 s55, s52, s46
    s_cmp_lt_u32 s64, 4
    s_cbranch_scc1 L_side
L_sideback:
    s_waitcnt vmcnt(4)
    s_barrier
    v_mfma_f32_32x32x16_bf16 v[80:95], v[64:67], v[112:115], 0
    buffer_load_dwordx4 v[112:115], v2, s[4:7], s52 offen offset:0 nt
    s_waitcnt vmcnt(5)
    v_mfma_f32_32x32x16_bf16 v[80:95], v[68:71], v[116:119], v[80:95]
    buffer_load_dwordx4 v[116:119], v2, s[4:7], s52 offen offset:256 nt
    s_waitcnt vmcnt(4)
    v_mfma_f32_32x32x16_bf16 v[80:95], v[72:75], v[120:123], v[80:95]
    buffer_load_dwordx4 v[120:123], v2, s[4:7], s52 offen offset:2048 nt
    s_waitcnt vmcnt(5)
    v_mfma_f32_32x32x16_bf16 v[80:95], v[76:79], v[124:127], v[80:95]
    buffer_load_dwordx4 v[124:127], v2, s[4:7], s52 offen offset:2304 nt
    s_waitcnt vmcnt(4)
    s_barrier
    v_mfma_f32_32x32x16_bf16 v[96:111], v[64:67], v[128:131], 0
    buffer_load_dwordx4 v[128:131], v2, s[4:7], s53 offen offset:0 nt
    s_waitcnt vmcnt(5)
    v_mfma_f32_32x32x16_bf16 v[96:111], v[68:71], v[132:135], v[96:111]
    buffer_load_dwordx4 v[132:135], v2, s[4:7], s53 offen offset:256 nt
    s_waitcnt vmcnt(4)
    v_mfma_f32_32x32x16_bf16 v[96:111], v[72:75], v[136:139], v[96:111]
    buffer_load_dwordx4 v[136:139], v2, s[4:7], s53 offen offset:2048 nt
    s_waitcnt vmcnt(5)
    v_mfma_f32_32x32x16_bf16 v[96:111], v[76:79], v[140:143], v[96:111]
    buffer_load_dwordx4 v[140:143], v2, s[4:7], s53 offen offset:2304 nt
    v_add_f32_dpp v36, v84, v80 row_shl:4 row_mask:0xf bank_mask:0x5
    v_add_f32_dpp v36, v88, v92 row_shr:4 row_mask:0xf bank_mask:0xa
    v_add_f32_dpp v37, v85, v81 row_shl:4 row_mask:0xf bank_mask:0x5
    v_add_f32_dpp v37, v89, v93 row_shr:4 row_mask:0xf bank_mask:0xa
    v_add_f32_dpp v38, v86, v82 row_shl:4 row_mask:0xf bank_mask:0x5
    v_add_f32_dpp v38, v90, v94 row_shr:4 row_mask:0xf bank_mask:0xa
    v_add_f32_dpp v39, v87, v83 row_shl:4 row_mask:0xf bank_mask:0x5
    v_add_f32_dpp v39, v91, v95 row_shr:4 row_mask:0xf bank_mask:0xa
    s_waitcnt vmcnt(4)
    s_barrier
    v_mfma_f32_32x32x16_bf16 v[80:95], v[64:67], v[144:147], 0
    buffer_load_dwordx4 v[144:147], v2, s[4:7], s54 offen offset:0 nt
    s_waitcnt vmcnt(5)
    v_mfma_f32_32x32x16_bf16 v[80:95], v[68:71], v[148:151], v[80:95]
    buffer_load_dwordx4 v[148:151], v2, s[4:7], s54 offen offset:256 nt
    s_waitcnt vmcnt(4)
    v_mfma_f32_32x32x16_bf16 v[80:95], v[72:75], v[152:155], v[80:95]
    buffer_load_dwordx4 v[152:155], v2, s[4:7], s54 offen offset:2048 nt
    s_waitcnt vmcnt(5)
    v_mfma_f32_32x32x16_bf16 v[80:95], v[76:79], v[156:159], v[80:95]
    buffer_load_dwordx4 v[156:159], v2, s[4:7], s54 offen offset:2304 nt
    v_add_f32_dpp v40, v100, v96 row_shl:4 row_mask:0xf bank_mask:0x5
    v_add_f32_dpp v40, v104, v108 row_shr:4 row_mask:0xf bank_mask:0xa
    v_add_f32_dpp v41, v101, v97 row_shl:4 row_mask:0xf bank_mask:0x5
    v_add_f32_dpp v41, v105, v109 row_shr:4 row_mask:0xf bank_mask:0xa
    v_add_f32_dpp v42, v102, v98 row_shl:4 row_mask:0xf bank_mask:0x5
    v_add_f32_dpp v42, v106, v110 row_shr:4 row_mask:0xf bank_mask:0xa
    v_add_f32_dpp v43, v103, v99 row_shl:4 row_mask:0xf bank_mask:0x5
    v_add_f32_dpp v43, v107, v111 row_shr:4 row_mask:0xf bank_mask:0xa
    s_nop 1
    v_add_f32_dpp v10, v38, v36 quad_perm:[2,3,0,1] row_mask:0xf bank_mask:0xf
    v_add_f32_dpp v11, v40, v42 quad_perm:[2,3,0,1] row_mask:0xf bank_mask:0xf
    v_cndmask_b32 v32, v10, v11, s[72:73]
    v_add_f32_dpp v10, v39, v37 quad_perm:[2,3,0,1] row_mask:0xf bank_mask:0xf
    v_add_f32_dpp v11, v41, v43 quad_perm:[2,3,0,1] row_mask:0xf bank_mask:0xf
    v_cndmask_b32 v33, v10, v11, s[72:73]
    s_waitcnt vmcnt(4)
    s_barrier
    v_mfma_f32_32x32x16_bf16 v[96:111], v[64:67], v[160:163], 0
    buffer_load_dwordx4 v[160:163], v2, s[4:7], s55 offen offset:0 nt
    s_waitcnt vmcnt(5)
    v_mfma_f32_32x32x16_bf16 v[96:111], v[68:71], v[164:167], v[96:111]
    buffer_load_dwordx4 v[164:167], v2, s[4:7], s55 offen offset:256 nt
    s_waitcnt vmcnt(4)
    v_mfma_f32_32x32x16_bf16 v[96:111], v[72:75], v[168:171], v[96:111]
    buffer_load_dwordx4 v[168:171], v2, s[4:7], s55 offen offset:2048 nt
    s_waitcnt vmcnt(5)
    v_mfma_f32_32x32x16_bf16 v[96:111], v[76:79], v[172:175], v[96:111]
    buffer_load_dwordx4 v[172:175], v2, s[4:7], s55 offen offset:2304 nt
    v_add_f32_dpp v36, v84, v80 row_shl:4 row_mask:0xf bank_mask:0x5
    v_add_f32_dpp v36, v88, v92 row_shr:4 row_mask:0xf bank_mask:0xa
    v_add_f32_dpp v37, v85, v81 row_shl:4 row_mask:0xf bank_mask:0x5
    v_add_f32_dpp v37, v89, v93 row_shr:4 row_mask:0xf bank_mask:0xa
    v_add_f32_dpp v38, v86, v82 row_shl:4 row_mask:0xf bank_mask:0x5
    v_add_f32_dpp v38, v90, v94 row_shr:4 row_mask:0xf bank_mask:0xa
    v_add_f32_dpp v39, v87, v83 row_shl:4 row_mask:0xf bank_mask:0x5
    v_add_f32_dpp v39, v91, v95 row_shr:4 row_mask:0xf bank_mask:0xa
    s_nop 3
    v_add_f32_dpp v40, v100, v96 row_shl:4 row_mask:0xf bank_mask:0x5
    v_add_f32_dpp v40, v104, v108 row_shr:4 row_mask:0xf bank_mask:0xa
    v_add_f32_dpp v41, v101, v97 row_shl:4 row_mask:0xf bank_mask:0x5
    v_add_f32_dpp v41, v105, v109 row_shr:4 row_mask:0xf bank_mask:0xa
    v_add_f32_dpp v42, v102, v98 row_shl:4 row_mask:0xf bank_mask:0x5
    v_add_f32_dpp v42, v106, v110 row_shr:4 row_mask:0xf bank_mask:0xa
    v_add_f32_dpp v43, v103, v99 row_shl:4 row_mask:0xf bank_mask:0x5
    v_add_f32_dpp v43, v107, v111 row_shr:4 row_mask:0xf bank_mask:0xa
    s_nop 1
    v_add_f32_dpp v10, v38, v36 quad_perm:[2,3,0,1] row_mask:0xf bank_mask:0xf
    v_add_f32_dpp v11, v40, v42 quad_perm:[2,3,0,1] row_mask:0xf bank_mask:0xf
    v_cndmask_b32 v34, v10, v11, s[72:73]
    v_add_f32_dpp v10, v39, v37 quad_perm:[2,3,0,1] row_mask:0xf bank_mask:0xf
    v_add_f32_dpp v11, v41, v43 quad_perm:[2,3,0,1] row_mask:0xf bank_mask:0xf
    v_cndmask_b32 v35, v10, v11, s[72:73]
    s_nop 1
    v_add_f32_dpp v10, v33, v32 quad_perm:[1,0,3,2] row_mask:0xf bank_mask:0xf
    v_add_f32_dpp v11, v34, v35 quad_perm:[1,0,3,2] row_mask:0xf bank_mask:0xf
    v_cndmask_b32 v8, v10, v11, s[74:75]
    v_cvt_pk_bf16_f32 v8, v8, v8
    v_and_b32 v8, 0xffff0000, v8
    ds_write_b32 v4, v8
    v_max_f32 v5, v5, v8
    v_add_u32 v4, 256, v4
    s_add_u32 s64, s64, 1
    s_cmp_lt_u32 s64, 14
    s_cbranch_scc1 L_ks
    s_mov_b32 s52, s60
    s_add_u32 s53, s52, 32768
    s_add_u32 s54, s52, 65536
    s_add_u32 s55, s52, 98304
    s_waitcnt vmcnt(4)
    s_barrier
    v_mfma_f32_32x32x16_bf16 v[80:95], v[64:67], v[112:115], 0
    buffer_load_dwordx4 v[112:115], v3, s[8:11], s52 offen offset:0 nt
    s_waitcnt vmcnt(5)
    v_mfma_f32_32x32x16_bf16 v[80:95], v[68:71], v[116:119], v[80:95]
    buffer_load_dwordx4 v[116:119], v3, s[8:11], s52 offen offset:256 nt
    s_waitcnt vmcnt(4)
    v_mfma_f32_32x32x16_bf16 v[80:95], v[72:75], v[120:123], v[80:95]
    buffer_load_dwordx4 v[120:123], v3, s[8:11], s52 offen offset:512 nt
    s_waitcnt vmcnt(5)
    v_mfma_f32_32x32x16_bf16 v[80:95], v[76:79], v[124:127], v[80:95]
    buffer_load_dwordx4 v[124:127], v3, s[8:11], s52 offen offset:768 nt
    s_waitcnt vmcnt(4)
    s_barrier
    v_mfma_f32_32x32x16_bf16 v[96:111], v[64:67], v[128:131], 0
    buffer_load_dwordx4 v[128:131], v3, s[8:11], s53 offen offset:0 nt
    s_waitcnt vmcnt(5)
    v_mfma_f32_32x32x16_bf16 v[96:111], v[68:71], v[132:135], v[96:111]
    buffer_load_dwordx4 v[132:135], v3, s[8:11], s53 offen offset:256 nt
    s_waitcnt vmcnt(4)
    v_mfma_f32_32x32x16_bf16 v[96:111], v[72:75], v[136:139], v[96:111]
    buffer_load_dwordx4 v[136:139], v3, s[8:11], s53 offen offset:512 nt
    s_waitcnt vmcnt(5)
    v_mfma_f32_32x32x16_bf16 v[96:111], v[76:79], v[140:143], v[96:111]
    buffer_load_dwordx4 v[140:143], v3, s[8:11], s53 offen offset:768 nt
    v_add_f32_dpp v36, v84, v80 row_shl:4 row_mask:0xf bank_mask:0x5
    v_add_f32_dpp v36, v88, v92 row_shr:4 row_mask:0xf bank_mask:0xa
    v_add_f32_dpp v37, v85, v81 row_shl:4 row_mask:0xf bank_mask:0x5
    v_add_f32_dpp v37, v89, v93 row_shr:4 row_mask:0xf bank_mask:0xa
    v_add_f32_dpp v38, v86, v82 row_shl:4 row_mask:0xf bank_mask:0x5
    v_add_f32_dpp v38, v90, v94 row_shr:4 row_mask:0xf bank_mask:0xa
    v_add_f32_dpp v39, v87, v83 row_shl:4 row_mask:0xf bank_mask:0x5
    v_add_f32_dpp v39, v91, v95 row_shr:4 row_mask:0xf bank_mask:0xa
    s_waitcnt vmcnt(4)
    s_barrier
    v_mfma_f32_32x32x16_bf16 v[80:95], v[64:67], v[144:147], 0
    buffer_load_dwordx4 v[144:147], v3, s[8:11], s54 offen offset:0 nt
    s_waitcnt vmcnt(5)
    v_mfma_f32_32x32x16_bf16 v[80:95], v[68:71], v[148:151], v[80:95]
    buffer_load_dwordx4 v[148:151], v3, s[8:11], s54 offen offset:256 nt
    s_waitcnt vmcnt(4)
    v_mfma_f32_32x32x16_bf16 v[80:95], v[72:75], v[152:155], v[80:95]
    buffer_load_dwordx4 v[152:155], v3, s[8:11], s54 offen offset:512 nt
    s_waitcnt vmcnt(5)
    v_mfma_f32_32x32x16_bf16 v[80:95], v[76:79], v[156:159], v[80:95]
    buffer_load_dwordx4 v[156:159], v3, s[8:11], s54 offen offset:768 nt
    v_add_f32_dpp v40, v100, v96 row_shl:4 row_mask:0xf bank_mask:0x5
    v_add_f32_dpp v40, v104, v108 row_shr:4 row_mask:0xf bank_mask:0xa
    v_add_f32_dpp v41, v101, v97 row_shl:4 row_mask:0xf bank_mask:0x5
    v_add_f32_dpp v41, v105, v109 row_shr:4 row_mask:0xf bank_mask:0xa
    v_add_f32_dpp v42, v102, v98 row_shl:4 row_mask:0xf bank_mask:0x5
    v_add_f32_dpp v42, v106, v110 row_shr:4 row_mask:0xf bank_mask:0xa
    v_add_f32_dpp v43, v103, v99 row_shl:4 row_mask:0xf bank_mask:0x5
    v_add_f32_dpp v43, v107, v111 row_shr:4 row_mask:0xf bank_mask:0xa
    s_nop 1
    v_add_f32_dpp v10, v38, v36 quad_perm:[2,3,0,1] row_mask:0xf bank_mask:0xf
    v_add_f32_dpp v11, v40, v42 quad_perm:[2,3,0,1] row_mask:0xf bank_mask:0xf
    v_cndmask_b32 v32, v10, v11, s[72:73]
    v_add_f32_dpp v10, v39, v37 quad_perm:[2,3,0,1] row_mask:0xf bank_mask:0xf
    v_add_f32_dpp v11, v41, v43 quad_perm:[2,3,0,1] row_mask:0xf bank_mask:0xf
    v_cndmask_b32 v33, v10, v11, s[72:73]
    s_waitcnt vmcnt(4)
    s_barrier
    v_mfma_f32_32x32x16_bf16 v[96:111], v[64:67], v[160:163], 0
    buffer_load_dwordx4 v[160:163], v3, s[8:11], s55 offen offset:0 nt
    s_waitcnt vmcnt(5)
    v_mfma_f32_32x32x16_bf16 v[96:111], v[68:71], v[164:167], v[96:111]
    buffer_load_dwordx4 v[164:167], v3, s[8:11], s55 offen offset:256 nt
    s_waitcnt vmcnt(4)
    v_mfma_f32_32x32x16_bf16 v[96:111], v[72:75], v[168:171], v[96:111]
    buffer_load_dwordx4 v[168:171], v3, s[8:11], s55 offen offset:512 nt
    s_waitcnt vmcnt(5)
    v_mfma_f32_32x32x16_bf16 v[96:111], v[76:79], v[172:175], v[96:111]
    buffer_load_dwordx4 v[172:175], v3, s[8:11], s55 offen offset:768 nt
    v_add_f32_dpp v36, v84, v80 row_shl:4 row_mask:0xf bank_mask:0x5
    v_add_f32_dpp v36, v88, v92 row_shr:4 row_mask:0xf bank_mask:0xa
    v_add_f32_dpp v37, v85, v81 row_shl:4 row_mask:0xf bank_mask:0x5
    v_add_f32_dpp v37, v89, v93 row_shr:4 row_mask:0xf bank_mask:0xa
    v_add_f32_dpp v38, v86, v82 row_shl:4 row_mask:0xf bank_mask:0x5
    v_add_f32_dpp v38, v90, v94 row_shr:4 row_mask:0xf bank_mask:0xa
    v_add_f32_dpp v39, v87, v83 row_shl:4 row_mask:0xf bank_mask:0x5
    v_add_f32_dpp v39, v91, v95 row_shr:4 row_mask:0xf bank_mask:0xa
    s_nop 3
    v_add_f32_dpp v40, v100, v96 row_shl:4 row_mask:0xf bank_mask:0x5
    v_add_f32_dpp v40, v104, v108 row_shr:4 row_mask:0xf bank_mask:0xa
    v_add_f32_dpp v41, v101, v97 row_shl:4 row_mask:0xf bank_mask:0x5
    v_add_f32_dpp v41, v105, v109 row_shr:4 row_mask:0xf bank_mask:0xa
    v_add_f32_dpp v42, v102, v98 row_shl:4 row_mask:0xf bank_mask:0x5
    v_add_f32_dpp v42, v106, v110 row_shr:4 row_mask:0xf bank_mask:0xa
    v_add_f32_dpp v43, v103, v99 row_shl:4 row_mask:0xf bank_mask:0x5
    v_add_f32_dpp v43, v107, v111 row_shr:4 row_mask:0xf bank_mask:0xa
    s_nop 1
    v_add_f32_dpp v10, v38, v36 quad_perm:[2,3,0,1] row_mask:0xf bank_mask:0xf
    v_add_f32_dpp v11, v40, v42 quad_perm:[2,3,0,1] row_mask:0xf bank_mask:0xf
    v_cndmask_b32 v34, v10, v11, s[72:73]
    v_add_f32_dpp v10, v39, v37 quad_perm:[2,3,0,1] row_mask:0xf bank_mask:0xf
    v_add_f32_dpp v11, v41, v43 quad_perm:[2,3,0,1] row_mask:0xf bank_mask:0xf
    v_cndmask_b32 v35, v10, v11, s[72:73]
    s_nop 1
    v_add_f32_dpp v10, v33, v32 quad_perm:[1,0,3,2] row_mask:0xf bank_mask:0xf
    v_add_f32_dpp v11, v34, v35 quad_perm:[1,0,3,2] row_mask:0xf bank_mask:0xf
    v_cndmask_b32 v8, v10, v11, s[74:75]
    v_cvt_pk_bf16_f32 v8, v8, v8
    v_and_b32 v8, 0xffff0000, v8
    ds_write_b32 v4, v8
    v_max_f32 v5, v5, v8
    v_add_u32 v4, 256, v4
    v_subrev_u32 v4, 3584, v4
    s_nop 1
    v_max_f32_dpp v5, v5, v5 quad_perm:[1,0,3,2] row_mask:0xf bank_mask:0xf
    s_nop 1
    v_max_f32_dpp v5, v5, v5 quad_perm:[2,3,0,1] row_mask:0xf bank_mask:0xf
    s_nop 1
    v_max_f32_dpp v5, v5, v5 row_ror:8 row_mask:0xf bank_mask:0xf
    v_mov_b32 v11, v5
    s_nop 1
    v_permlane16_swap_b32 v5, v11
    s_nop 0
    v_max_f32 v5, v5, v11
    v_mov_b32 v11, v5
    s_nop 1
    v_permlane32_swap_b32 v5, v11
    s_nop 0
    v_max_f32 v5, v5, v11
    ds_read_b32 v9, v4
    s_add_u32 s52, s52, 131072
    s_add_u32 s53, s52, 32768
    s_add_u32 s54, s52, 65536
    s_add_u32 s55, s52, 98304
    s_waitcnt lgkmcnt(0)
    v_sub_f32 v10, v9, v5
    v_mul_f32 v10, s70, v10
    v_exp_f32 v10, v10
    s_nop 0
    v_cvt_pk_bf16_f32 v14, v10, v10
    v_add_f32 v6, v6, v10
    s_nop 0
    v_add_u32 v4, 256, v4
    ds_read_b32 v9, v4
    v_mov_b32_dpp v16, v14 row_newbcast:0 row_mask:0xf bank_mask:0x3
    v_mov_b32_dpp v16, v14 row_newbcast:4 row_mask:0xf bank_mask:0xc
    v_and_b32 v44, v16, v52
    v_and_b32 v45, v16, v53
    v_and_b32 v46, v16, v54
    v_and_b32 v47, v16, v55
    s_waitcnt vmcnt(4)
    s_barrier
    v_mfma_f32_16x16x32_bf16 v[56:59], v[112:115], v[44:47], v[56:59]
    buffer_load_dwordx4 v[112:115], v3, s[8:11], s52 offen offset:0 nt
    s_waitcnt vmcnt(5)
    v_mfma_f32_16x16x32_bf16 v[60:63], v[116:119], v[44:47], v[60:63]
    buffer_load_dwordx4 v[116:119], v3, s[8:11], s52 offen offset:256 nt
    v_mov_b32_dpp v17, v14 row_newbcast:8 row_mask:0xf bank_mask:0x3
    v_mov_b32_dpp v17, v14 row_newbcast:12 row_mask:0xf bank_mask:0xc
    v_and_b32 v48, v17, v52
    v_and_b32 v49, v17, v53
    v_and_b32 v50, v17, v54
    v_and_b32 v51, v17, v55
    s_waitcnt vmcnt(4)
    s_nop 0
    v_mfma_f32_16x16x32_bf16 v[56:59], v[120:123], v[48:51], v[56:59]
    buffer_load_dwordx4 v[120:123], v3, s[8:11], s52 offen offset:512 nt
    s_waitcnt vmcnt(5)
    v_mfma_f32_16x16x32_bf16 v[60:63], v[124:127], v[48:51], v[60:63]
    buffer_load_dwordx4 v[124:127], v3, s[8:11], s52 offen offset:768 nt
    v_mov_b32_dpp v16, v14 row_newbcast:2 row_mask:0xf bank_mask:0x3
    v_mov_b32_dpp v16, v14 row_newbcast:6 row_mask:0xf bank_mask:0xc
    v_and_b32 v44, v16, v52
    v_and_b32 v45, v16, v53
    v_and_b32 v46, v16, v54
    v_and_b32 v47, v16, v55
    s_waitcnt vmcnt(4)
    s_barrier
    v_mfma_f32_16x16x32_bf16 v[56:59], v[128:131], v[44:47], v[56:59]
    buffer_load_dwordx4 v[128:131], v3, s[8:11], s53 offen offset:0 nt
    s_waitcnt vmcnt(5)
    v_mfma_f32_16x16x32_bf16 v[60:63], v[132:135], v[44:47], v[60:63]
    buffer_load_dwordx4 v[132:135], v3, s[8:11], s53 offen offset:256 nt
    v_mov_b32_dpp v17, v14 row_newbcast:10 row_mask:0xf bank_mask:0x3
    v_mov_b32_dpp v17, v14 row_newbcast:14 row_mask:0xf bank_mask:0xc
    v_and_b32 v48, v17, v52
    v_and_b32 v49, v17, v53
    v_and_b32 v50, v17, v54
    v_and_b32 v51, v17, v55
    s_waitcnt vmcnt(4)
    s_nop 0
    v_mfma_f32_16x16x32_bf16 v[56:59], v[136:139], v[48:51], v[56:59]
    buffer_load_dwordx4 v[136:139], v3, s[8:11], s53 offen offset:512 nt
    s_waitcnt vmcnt(5)
    v_mfma_f32_16x16x32_bf16 v[60:63], v[140:143], v[48:51], v[60:63]
    buffer_load_dwordx4 v[140:143], v3, s[8:11], s53 offen offset:768 nt
    v_mov_b32_dpp v16, v14 row_newbcast:1 row_mask:0xf bank_mask:0x3
    v_mov_b32_dpp v16, v14 row_newbcast:5 row_mask:0xf bank_mask:0xc
    v_and_b32 v44, v16, v52
    v_and_b32 v45, v16, v53
    v_and_b32 v46, v16, v54
    v_and_b32 v47, v16, v55
    s_waitcnt vmcnt(4)
    s_barrier
    v_mfma_f32_16x16x32_bf16 v[56:59], v[144:147], v[44:47], v[56:59]
    buffer_load_dwordx4 v[144:147], v3, s[8:11], s54 offen offset:0 nt
    s_waitcnt vmcnt(5)
    v_mfma_f32_16x16x32_bf16 v[60:63], v[148:151], v[44:47], v[60:63]
    buffer_load_dwordx4 v[148:151], v3, s[8:11], s54 offen offset:256 nt
    v_mov_b32_dpp v17, v14 row_newbcast:9 row_mask:0xf bank_mask:0x3
    v_mov_b32_dpp v17, v14 row_newbcast:13 row_mask:0xf bank_mask:0xc
    v_and_b32 v48, v17, v52
    v_and_b32 v49, v17, v53
    v_and_b32 v50, v17, v54
    v_and_b32 v51, v17, v55
    s_waitcnt vmcnt(4)
    s_nop 0
    v_mfma_f32_16x16x32_bf16 v[56:59], v[152:155], v[48:51], v[56:59]
    buffer_load_dwordx4 v[152:155], v3, s[8:11], s54 offen offset:512 nt
    s_waitcnt vmcnt(5)
    v_mfma_f32_16x16x32_bf16 v[60:63], v[156:159], v[48:51], v[60:63]
    buffer_load_dwordx4 v[156:159], v3, s[8:11], s54 offen offset:768 nt
    v_mov_b32_dpp v16, v14 row_newbcast:3 row_mask:0xf bank_mask:0x3
    v_mov_b32_dpp v16, v14 row_newbcast:7 row_mask:0xf bank_mask:0xc
    v_and_b32 v44, v16, v52
    v_and_b32 v45, v16, v53
    v_and_b32 v46, v16, v54
    v_and_b32 v47, v16, v55
    s_waitcnt vmcnt(4)
    s_barrier
    v_mfma_f32_16x16x32_bf16 v[56:59], v[160:163], v[44:47], v[56:59]
    buffer_load_dwordx4 v[160:163], v3, s[8:11], s55 offen offset:0 nt
    s_waitcnt vmcnt(5)
    v_mfma_f32_16x16x32_bf16 v[60:63], v[164:167], v[44:47], v[60:63]
    buffer_load_dwordx4 v[164:167], v3, s[8:11], s55 offen offset:256 nt
    v_mov_b32_dpp v17, v14 row_newbcast:11 row_mask:0xf bank_mask:0x3
    v_mov_b32_dpp v17, v14 row_newbcast:15 row_mask:0xf bank_mask:0xc
    v_and_b32 v48, v17, v52
    v_and_b32 v49, v17, v53
    v_and_b32 v50, v17, v54
    v_and_b32 v51, v17, v55
    s_waitcnt vmcnt(4)
    s_nop 0
    v_mfma_f32_16x16x32_bf16 v[56:59], v[168:171], v[48:51], v[56:59]
    buffer_load_dwordx4 v[168:171], v3, s[8:11], s55 offen offset:512 nt
    s_waitcnt vmcnt(5)
    v_mfma_f32_16x16x32_bf16 v[60:63], v[172:175], v[48:51], v[60:63]
    buffer_load_dwordx4 v[172:175], v3, s[8:11], s55 offen offset:768 nt
    s_mov_b32 s52, s47
    s_mov_b32 s64, 2
L_vs:
    s_add_u32 s52, s52, 131072
    s_and_b32 s52, s52, 0x1fffff
    s_add_u32 s52, s52, s43
    s_add_u32 s53, s52, s44
    s_add_u32 s54, s52, s45
    s_add_u32 s55, s52, s46
    s_waitcnt lgkmcnt(0)
    v_sub_f32 v10, v9, v5
    v_mul_f32 v10, s70, v10
    v_exp_f32 v10, v10
    s_nop 0
    v_cvt_pk_bf16_f32 v14, v10, v10
    v_add_f32 v6, v6, v10
    s_nop 0
    v_add_u32 v4, 256, v4
    ds_read_b32 v9, v4
    v_mov_b32_dpp v16, v14 row_newbcast:0 row_mask:0xf bank_mask:0x3
    v_mov_b32_dpp v16, v14 row_newbcast:4 row_mask:0xf bank_mask:0xc
    v_and_b32 v44, v16, v52
    v_and_b32 v45, v16, v53
    v_and_b32 v46, v16, v54
    v_and_b32 v47, v16, v55
    s_waitcnt vmcnt(4)
    s_barrier
    v_mfma_f32_16x16x32_bf16 v[56:59], v[112:115], v[44:47], v[56:59]
    buffer_load_dwordx4 v[112:115], v3, s[8:11], s52 offen offset:0 nt
    s_waitcnt vmcnt(5)
    v_mfma_f32_16x16x32_bf16 v[60:63], v[116:119], v[44:47], v[60:63]
    buffer_load_dwordx4 v[116:119], v3, s[8:11], s52 offen offset:256 nt
    v_mov_b32_dpp v17, v14 row_newbcast:8 row_mask:0xf bank_mask:0x3
    v_mov_b32_dpp v17, v14 row_newbcast:12 row_mask:0xf bank_mask:0xc
    v_and_b32 v48, v17, v52
    v_and_b32 v49, v17, v53
    v_and_b32 v50, v17, v54
    v_and_b32 v51, v17, v55
    s_waitcnt vmcnt(4)
    s_nop 0
    v_mfma_f32_16x16x32_bf16 v[56:59], v[120:123], v[48:51], v[56:59]
    buffer_load_dwordx4 v[120:123], v3, s[8:11], s52 offen offset:512 nt
    s_waitcnt vmcnt(5)
    v_mfma_f32_16x16x32_bf16 v[60:63], v[124:127], v[48:51], v[60:63]
    buffer_load_dwordx4 v[124:127], v3, s[8:11], s52 offen offset:768 nt
    v_mov_b32_dpp v16, v14 row_newbcast:2 row_mask:0xf bank_mask:0x3
    v_mov_b32_dpp v16, v14 row_newbcast:6 row_mask:0xf bank_mask:0xc
    v_and_b32 v44, v16, v52
    v_and_b32 v45, v16, v53
    v_and_b32 v46, v16, v54
    v_and_b32 v47, v16, v55
    s_waitcnt vmcnt(4)
    s_barrier
    v_mfma_f32_16x16x32_bf16 v[56:59], v[128:131], v[44:47], v[56:59]
    buffer_load_dwordx4 v[128:131], v3, s[8:11], s53 offen offset:0 nt
    s_waitcnt vmcnt(5)
    v_mfma_f32_16x16x32_bf16 v[60:63], v[132:135], v[44:47], v[60:63]
    buffer_load_dwordx4 v[132:135], v3, s[8:11], s53 offen offset:256 nt
    v_mov_b32_dpp v17, v14 row_newbcast:10 row_mask:0xf bank_mask:0x3
    v_mov_b32_dpp v17, v14 row_newbcast:14 row_mask:0xf bank_mask:0xc
    v_and_b32 v48, v17, v52
    v_and_b32 v49, v17, v53
    v_and_b32 v50, v17, v54
    v_and_b32 v51, v17, v55
    s_waitcnt vmcnt(4)
    s_nop 0
    v_mfma_f32_16x16x32_bf16 v[56:59], v[136:139], v[48:51], v[56:59]
    buffer_load_dwordx4 v[136:139], v3, s[8:11], s53 offen offset:512 nt
    s_waitcnt vmcnt(5)
    v_mfma_f32_16x16x32_bf16 v[60:63], v[140:143], v[48:51], v[60:63]
    buffer_load_dwordx4 v[140:143], v3, s[8:11], s53 offen offset:768 nt
    v_mov_b32_dpp v16, v14 row_newbcast:1 row_mask:0xf bank_mask:0x3
    v_mov_b32_dpp v16, v14 row_newbcast:5 row_mask:0xf bank_mask:0xc
    v_and_b32 v44, v16, v52
    v_and_b32 v45, v16, v53
    v_and_b32 v46, v16, v54
    v_and_b32 v47, v16, v55
    s_waitcnt vmcnt(4)
    s_barrier
    v_mfma_f32_16x16x32_bf16 v[56:59], v[144:147], v[44:47], v[56:59]
    buffer_load_dwordx4 v[144:147], v3, s[8:11], s54 offen offset:0 nt
    s_waitcnt vmcnt(5)
    v_mfma_f32_16x16x32_bf16 v[60:63], v[148:151], v[44:47], v[60:63]
    buffer_load_dwordx4 v[148:151], v3, s[8:11], s54 offen offset:256 nt
    v_mov_b32_dpp v17, v14 row_newbcast:9 row_mask:0xf bank_mask:0x3
    v_mov_b32_dpp v17, v14 row_newbcast:13 row_mask:0xf bank_mask:0xc
    v_and_b32 v48, v17, v52
    v_and_b32 v49, v17, v53
    v_and_b32 v50, v17, v54
    v_and_b32 v51, v17, v55
    s_waitcnt vmcnt(4)
    s_nop 0
    v_mfma_f32_16x16x32_bf16 v[56:59], v[152:155], v[48:51], v[56:59]
    buffer_load_dwordx4 v[152:155], v3, s[8:11], s54 offen offset:512 nt
    s_waitcnt vmcnt(5)
    v_mfma_f32_16x16x32_bf16 v[60:63], v[156:159], v[48:51], v[60:63]
    buffer_load_dwordx4 v[156:159], v3, s[8:11], s54 offen offset:768 nt
    v_mov_b32_dpp v16, v14 row_newbcast:3 row_mask:0xf bank_mask:0x3
    v_mov_b32_dpp v16, v14 row_newbcast:7 row_mask:0xf bank_mask:0xc
    v_and_b32 v44, v16, v52
    v_and_b32 v45, v16, v53
    v_and_b32 v46, v16, v54
    v_and_b32 v47, v16, v55
    s_waitcnt vmcnt(4)
    s_barrier
    v_mfma_f32_16x16x32_bf16 v[56:59], v[160:163], v[44:47], v[56:59]
    buffer_load_dwordx4 v[160:163], v3, s[8:11], s55 offen offset:0 nt
    s_waitcnt vmcnt(5)
    v_mfma_f32_16x16x32_bf16 v[60:63], v[164:167], v[44:47], v[60:63]
    buffer_load_dwordx4 v[164:167], v3, s[8:11], s55 offen offset:256 nt
    v_mov_b32_dpp v17, v14 row_newbcast:11 row_mask:0xf bank_mask:0x3
    v_mov_b32_dpp v17, v14 row_newbcast:15 row_mask:0xf bank_mask:0xc
    v_and_b32 v48, v17, v52
    v_and_b32 v49, v17, v53
    v_and_b32 v50, v17, v54
    v_and_b32 v51, v17, v55
    s_waitcnt vmcnt(4)
    s_nop 0
    v_mfma_f32_16x16x32_bf16 v[56:59], v[168:171], v[48:51], v[56:59]
    buffer_load_dwordx4 v[168:171], v3, s[8:11], s55 offen offset:512 nt
    s_waitcnt vmcnt(5)
    v_mfma_f32_16x16x32_bf16 v[60:63], v[172:175], v[48:51], v[60:63]
    buffer_load_dwordx4 v[172:175], v3, s[8:11], s55 offen offset:768 nt
    s_add_u32 s64, s64, 1
    s_cmp_lt_u32 s64, 14
    s_cbranch_scc1 L_vs
    s_waitcnt lgkmcnt(0)
    v_sub_f32 v10, v9, v5
    v_mul_f32 v10, s70, v10
    v_exp_f32 v10, v10
    s_nop 0
    v_cvt_pk_bf16_f32 v14, v10, v10
    v_add_f32 v6, v6, v10
    s_nop 0
    s_mov_b32 s88, 1
    s_atomic_add s88, s[86:87], 0 glc
    v_mov_b32_dpp v16, v14 row_newbcast:0 row_mask:0xf bank_mask:0x3
    v_mov_b32_dpp v16, v14 row_newbcast:4 row_mask:0xf bank_mask:0xc
    v_and_b32 v44, v16, v52
    v_and_b32 v45, v16, v53
    v_and_b32 v46, v16, v54
    v_and_b32 v47, v16, v55
    s_waitcnt vmcnt(4)
    s_barrier
    v_mfma_f32_16x16x32_bf16 v[56:59], v[112:115], v[44:47], v[56:59]
    buffer_load_dwordx4 v[112:115], v2, s[4:7], s61 offen offset:0 nt
    s_waitcnt vmcnt(5)
    v_mfma_f32_16x16x32_bf16 v[60:63], v[116:119], v[44:47], v[60:63]
    buffer_load_dwordx4 v[116:119], v2, s[4:7], s61 offen offset:256 nt
    v_mov_b32_dpp v17, v14 row_newbcast:8 row_mask:0xf bank_mask:0x3
    v_mov_b32_dpp v17, v14 row_newbcast:12 row_mask:0xf bank_mask:0xc
    v_and_b32 v48, v17, v52
    v_and_b32 v49, v17, v53
    v_and_b32 v50, v17, v54
    v_and_b32 v51, v17, v55
    s_waitcnt vmcnt(4)
    s_nop 0
    v_mfma_f32_16x16x32_bf16 v[56:59], v[120:123], v[48:51], v[56:59]
    buffer_load_dwordx4 v[120:123], v2, s[4:7], s61 offen offset:2048 nt
    s_waitcnt vmcnt(5)
    v_mfma_f32_16x16x32_bf16 v[60:63], v[124:127], v[48:51], v[60:63]
    buffer_load_dwordx4 v[124:127], v2, s[4:7], s61 offen offset:2304 nt
    v_mov_b32_dpp v16, v14 row_newbcast:2 row_mask:0xf bank_mask:0x3
    v_mov_b32_dpp v16, v14 row_newbcast:6 row_mask:0xf bank_mask:0xc
    v_and_b32 v44, v16, v52
    v_and_b32 v45, v16, v53
    v_and_b32 v46, v16, v54
    v_and_b32 v47, v16, v55
    s_waitcnt vmcnt(4)
    s_barrier
    v_mfma_f32_16x16x32_bf16 v[56:59], v[128:131], v[44:47], v[56:59]
    buffer_load_dwordx4 v[128:131], v3, s[8:11], s61 offen offset:0 nt
    s_waitcnt vmcnt(5)
    v_mfma_f32_16x16x32_bf16 v[60:63], v[132:135], v[44:47], v[60:63]
    buffer_load_dwordx4 v[132:135], v3, s[8:11], s61 offen offset:256 nt
    v_mov_b32_dpp v17, v14 row_newbcast:10 row_mask:0xf bank_mask:0x3
    v_mov_b32_dpp v17, v14 row_newbcast:14 row_mask:0xf bank_mask:0xc
    v_and_b32 v48, v17, v52
    v_and_b32 v49, v17, v53
    v_and_b32 v50, v17, v54
    v_and_b32 v51, v17, v55
    s_waitcnt vmcnt(4)
    s_nop 0
    v_mfma_f32_16x16x32_bf16 v[56:59], v[136:139], v[48:51], v[56:59]
    buffer_load_dwordx4 v[136:139], v3, s[8:11], s61 offen offset:512 nt
    s_waitcnt vmcnt(5)
    v_mfma_f32_16x16x32_bf16 v[60:63], v[140:143], v[48:51], v[60:63]
    buffer_load_dwordx4 v[140:143], v3, s[8:11], s61 offen offset:768 nt
    v_mov_b32_dpp v16, v14 row_newbcast:1 row_mask:0xf bank_mask:0x3
    v_mov_b32_dpp v16, v14 row_newbcast:5 row_mask:0xf bank_mask:0xc
    v_and_b32 v44, v16, v52
    v_and_b32 v45, v16, v53
    v_and_b32 v46, v16, v54
    v_and_b32 v47, v16, v55
    s_waitcnt vmcnt(4)
    s_barrier
    v_mfma_f32_16x16x32_bf16 v[56:59], v[144:147], v[44:47], v[56:59]
    buffer_load_dwordx4 v[144:147], v2, s[4:7], s62 offen offset:0 nt
    s_waitcnt vmcnt(5)
    v_mfma_f32_16x16x32_bf16 v[60:63], v[148:151], v[44:47], v[60:63]
    buffer_load_dwordx4 v[148:151], v2, s[4:7], s62 offen offset:256 nt
    v_mov_b32_dpp v17, v14 row_newbcast:9 row_mask:0xf bank_mask:0x3
    v_mov_b32_dpp v17, v14 row_newbcast:13 row_mask:0xf bank_mask:0xc
    v_and_b32 v48, v17, v52
    v_and_b32 v49, v17, v53
    v_and_b32 v50, v17, v54
    v_and_b32 v51, v17, v55
    s_waitcnt vmcnt(4)
    s_nop 0
    v_mfma_f32_16x16x32_bf16 v[56:59], v[152:155], v[48:51], v[56:59]
    buffer_load_dwordx4 v[152:155], v2, s[4:7], s62 offen offset:2048 nt
    s_waitcnt vmcnt(5)
    v_mfma_f32_16x16x32_bf16 v[60:63], v[156:159], v[48:51], v[60:63]
    buffer_load_dwordx4 v[156:159], v2, s[4:7], s62 offen offset:2304 nt
    v_mov_b32_dpp v16, v14 row_newbcast:3 row_mask:0xf bank_mask:0x3
    v_mov_b32_dpp v16, v14 row_newbcast:7 row_mask:0xf bank_mask:0xc
    v_and_b32 v44, v16, v52
    v_and_b32 v45, v16, v53
    v_and_b32 v46, v16, v54
    v_and_b32 v47, v16, v55
    s_waitcnt vmcnt(4)
    s_barrier
    v_mfma_f32_16x16x32_bf16 v[56:59], v[160:163], v[44:47], v[56:59]
    buffer_load_dwordx4 v[160:163], v3, s[8:11], s62 offen offset:0 nt
    s_waitcnt vmcnt(5)
    v_mfma_f32_16x16x32_bf16 v[60:63], v[164:167], v[44:47], v[60:63]
    buffer_load_dwordx4 v[164:167], v3, s[8:11], s62 offen offset:256 nt
    v_mov_b32_dpp v17, v14 row_newbcast:11 row_mask:0xf bank_mask:0x3
    v_mov_b32_dpp v17, v14 row_newbcast:15 row_mask:0xf bank_mask:0xc
    v_and_b32 v48, v17, v52
    v_and_b32 v49, v17, v53
    v_and_b32 v50, v17, v54
    v_and_b32 v51, v17, v55
    s_waitcnt vmcnt(4)
    s_nop 0
    v_mfma_f32_16x16x32_bf16 v[56:59], v[168:171], v[48:51], v[56:59]
    buffer_load_dwordx4 v[168:171], v3, s[8:11], s62 offen offset:512 nt
    s_waitcnt vmcnt(5)
    v_mfma_f32_16x16x32_bf16 v[60:63], v[172:175], v[48:51], v[60:63]
    buffer_load_dwordx4 v[172:175], v3, s[8:11], s62 offen offset:768 nt
L_dyn:
    s_waitcnt lgkmcnt(0)
    s_mov_b32 s67, s88
    s_cmp_ge_u32 s67, 96
    s_cbranch_scc1 L_drain0
    s_mov_b32 s88, 1
    s_atomic_add s88, s[86:87], 0 glc
    s_mul_i32 s82, s67, 43
    s_lshr_b32 s82, s82, 9
    s_mul_i32 s82, s82, 116
    s_add_u32 s82, s82, s67
    s_lshl_b32 s82, s82, 14
    s_add_u32 s63, s69, s82
    s_cmp_ge_u32 s67, 88
    s_waitcnt vmcnt(15)
    s_cbranch_scc1 L_np0
    s_waitcnt vmcnt(5)
L_np0:
    v_mfma_f32_32x32x16_bf16 v[80:95], v[64:67], v[112:115], 0
    buffer_load_dwordx4 v[112:115], v2, s[4:7], s63 offen offset:0 nt
    s_waitcnt vmcnt(15)
    s_cbranch_scc1 L_np1
    s_waitcnt vmcnt(5)
L_np1:
    v_mfma_f32_32x32x16_bf16 v[80:95], v[68:71], v[116:119], v[80:95]
    buffer_load_dwordx4 v[116:119], v2, s[4:7], s63 offen offset:256 nt
    s_waitcnt vmcnt(15)
    s_cbranch_scc1 L_np2
    s_waitcnt vmcnt(5)
L_np2:
    v_mfma_f32_32x32x16_bf16 v[80:95], v[72:75], v[120:123], v[80:95]
    buffer_load_dwordx4 v[120:123], v2, s[4:7], s63 offen offset:2048 nt
    s_waitcnt vmcnt(15)
    s_cbranch_scc1 L_np3
    s_waitcnt vmcnt(5)
L_np3:
    v_mfma_f32_32x32x16_bf16 v[80:95], v[76:79], v[124:127], v[80:95]
    buffer_load_dwordx4 v[124:127], v2, s[4:7], s63 offen offset:2304 nt
    s_nop 11
    v_add_f32_dpp v36, v84, v80 row_shl:4 row_mask:0xf bank_mask:0x5
    v_add_f32_dpp v36, v88, v92 row_shr:4 row_mask:0xf bank_mask:0xa
    v_add_f32_dpp v37, v85, v81 row_shl:4 row_mask:0xf bank_mask:0x5
    v_add_f32_dpp v37, v89, v93 row_shr:4 row_mask:0xf bank_mask:0xa
    v_add_f32_dpp v38, v86, v82 row_shl:4 row_mask:0xf bank_mask:0x5
    v_add_f32_dpp v38, v90, v94 row_shr:4 row_mask:0xf bank_mask:0xa
    v_add_f32_dpp v39, v87, v83 row_shl:4 row_mask:0xf bank_mask:0x5
    v_add_f32_dpp v39, v91, v95 row_shr:4 row_mask:0xf bank_mask:0xa
    s_nop 1
    v_add_f32_dpp v32, v38, v36 quad_perm:[2,3,0,1] row_mask:0xf bank_mask:0xf
    v_add_f32_dpp v33, v39, v37 quad_perm:[2,3,0,1] row_mask:0xf bank_mask:0xf
    s_nop 1
    v_add_f32_dpp v10, v33, v32 quad_perm:[1,0,3,2] row_mask:0xf bank_mask:0xf
    s_nop 1
    v_mov_b32_dpp v8, v10 quad_perm:[0,0,0,0] row_mask:0xf bank_mask:0xf
    v_cvt_pk_bf16_f32 v8, v8, v8
    v_and_b32 v8, 0xffff0000, v8
    v_cmp_gt_f32 vcc, v8, v5
    s_cbranch_vccnz L_rare4
L_back4:
    v_sub_f32 v10, v8, v5
    v_mul_f32 v10, s70, v10
    v_exp_f32 v10, v10
    s_nop 0
    v_cvt_pk_bf16_f32 v14, v10, v10
    v_add_f32 v7, v7, v10
    s_nop 0
    v_mov_b32_dpp v16, v14 row_newbcast:0 row_mask:0xf bank_mask:0x3
    v_mov_b32_dpp v16, v14 row_newbcast:4 row_mask:0xf bank_mask:0xc
    v_and_b32 v44, v16, v52
    v_and_b32 v45, v16, v53
    v_and_b32 v46, v16, v54
    v_and_b32 v47, v16, v55
    s_waitcnt vmcnt(15)
    s_cbranch_scc1 L_np5
    s_waitcnt vmcnt(5)
L_np5:
    s_nop 0
    v_mfma_f32_16x16x32_bf16 v[56:59], v[128:131], v[44:47], v[56:59]
    buffer_load_dwordx4 v[128:131], v3, s[8:11], s63 offen offset:0 nt
    s_waitcnt vmcnt(15)
    s_cbranch_scc1 L_np6
    s_waitcnt vmcnt(5)
L_np6:
    v_mfma_f32_16x16x32_bf16 v[60:63], v[132:135], v[44:47], v[60:63]
    buffer_load_dwordx4 v[132:135], v3, s[8:11], s63 offen offset:256 nt
    v_mov_b32_dpp v17, v14 row_newbcast:8 row_mask:0xf bank_mask:0x3
    v_mov_b32_dpp v17, v14 row_newbcast:12 row_mask:0xf bank_mask:0xc
    v_and_b32 v48, v17, v52
    v_and_b32 v49, v17, v53
    v_and_b32 v50, v17, v54
    v_and_b32 v51, v17, v55
    s_waitcnt vmcnt(15)
    s_cbranch_scc1 L_np7
    s_waitcnt vmcnt(5)
L_np7:
    s_nop 0
    v_mfma_f32_16x16x32_bf16 v[56:59], v[136:139], v[48:51], v[56:59]
    buffer_load_dwordx4 v[136:139], v3, s[8:11], s63 offen offset:512 nt
    s_waitcnt vmcnt(15)
    s_cbranch_scc1 L_np8
    s_waitcnt vmcnt(5)
L_np8:
    v_mfma_f32_16x16x32_bf16 v[60:63], v[140:143], v[48:51], v[60:63]
    buffer_load_dwordx4 v[140:143], v3, s[8:11], s63 offen offset:768 nt
    s_waitcnt lgkmcnt(0)
    s_mov_b32 s67, s88
    s_cmp_ge_u32 s67, 96
    s_cbranch_scc1 L_drain1
    s_mov_b32 s88, 1
    s_atomic_add s88, s[86:87], 0 glc
    s_mul_i32 s82, s67, 43
    s_lshr_b32 s82, s82, 9
    s_mul_i32 s82, s82, 116
    s_add_u32 s82, s82, s67
    s_lshl_b32 s82, s82, 14
    s_add_u32 s63, s69, s82
    s_cmp_ge_u32 s67, 88
    s_waitcnt vmcnt(15)
    s_cbranch_scc1 L_np9
    s_waitcnt vmcnt(5)
L_np9:
    v_mfma_f32_32x32x16_bf16 v[80:95], v[64:67], v[144:147], 0
    buffer_load_dwordx4 v[144:147], v2, s[4:7], s63 offen offset:0 nt
    s_waitcnt vmcnt(15)
    s_cbranch_scc1 L_np10
    s_waitcnt vmcnt(5)
L_np10:
    v_mfma_f32_32x32x16_bf16 v[80:95], v[68:71], v[148:151], v[80:95]
    buffer_load_dwordx4 v[148:151], v2, s[4:7], s63 offen offset:256 nt
    s_waitcnt vmcnt(15)
    s_cbranch_scc1 L_np11
    s_waitcnt vmcnt(5)
L_np11:
    v_mfma_f32_32x32x16_bf16 v[80:95], v[72:75], v[152:155], v[80:95]
    buffer_load_dwordx4 v[152:155], v2, s[4:7], s63 offen offset:2048 nt
    s_waitcnt vmcnt(15)
    s_cbranch_scc1 L_np12
    s_waitcnt vmcnt(5)
L_np12:
    v_mfma_f32_32x32x16_bf16 v[80:95], v[76:79], v[156:159], v[80:95]
    buffer_load_dwordx4 v[156:159], v2, s[4:7], s63 offen offset:2304 nt
    s_nop 11
    v_add_f32_dpp v36, v84, v80 row_shl:4 row_mask:0xf bank_mask:0x5
    v_add_f32_dpp v36, v88, v92 row_shr:4 row_mask:0xf bank_mask:0xa
    v_add_f32_dpp v37, v85, v81 row_shl:4 row_mask:0xf bank_mask:0x5
    v_add_f32_dpp v37, v89, v93 row_shr:4 row_mask:0xf bank_mask:0xa
    v_add_f32_dpp v38, v86, v82 row_shl:4 row_mask:0xf bank_mask:0x5
    v_add_f32_dpp v38, v90, v94 row_shr:4 row_mask:0xf bank_mask:0xa
    v_add_f32_dpp v39, v87, v83 row_shl:4 row_mask:0xf bank_mask:0x5
    v_add_f32_dpp v39, v91, v95 row_shr:4 row_mask:0xf bank_mask:0xa
    s_nop 1
    v_add_f32_dpp v32, v38, v36 quad_perm:[2,3,0,1] row_mask:0xf bank_mask:0xf
    v_add_f32_dpp v33, v39, v37 quad_perm:[2,3,0,1] row_mask:0xf bank_mask:0xf
    s_nop 1
    v_add_f32_dpp v10, v33, v32 quad_perm:[1,0,3,2] row_mask:0xf bank_mask:0xf
    s_nop 1
    v_mov_b32_dpp v8, v10 quad_perm:[0,0,0,0] row_mask:0xf bank_mask:0xf
    v_cvt_pk_bf16_f32 v8, v8, v8
    v_and_b32 v8, 0xffff0000, v8
    v_cmp_gt_f32 vcc, v8, v5
    s_cbranch_vccnz L_rare13
L_back13:
    v_sub_f32 v10, v8, v5
    v_mul_f32 v10, s70, v10
    v_exp_f32 v10, v10
    s_nop 0
    v_cvt_pk_bf16_f32 v14, v10, v10
    v_add_f32 v7, v7, v10
    s_nop 0
    v_mov_b32_dpp v16, v14 row_newbcast:0 row_mask:0xf bank_mask:0x3
    v_mov_b32_dpp v16, v14 row_newbcast:4 row_mask:0xf bank_mask:0xc
    v_and_b32 v44, v16, v52
    v_and_b32 v45, v16, v53
    v_and_b32 v46, v16, v54
    v_and_b32 v47, v16, v55
    s_waitcnt vmcnt(15)
    s_cbranch_scc1 L_np14
    s_waitcnt vmcnt(5)
L_np14:
    s_nop 0
    v_mfma_f32_16x16x32_bf16 v[56:59], v[160:163], v[44:47], v[56:59]
    buffer_load_dwordx4 v[160:163], v3, s[8:11], s63 offen offset:0 nt
    s_waitcnt vmcnt(15)
    s_cbranch_scc1 L_np15
    s_waitcnt vmcnt(5)
L_np15:
    v_mfma_f32_16x16x32_bf16 v[60:63], v[164:167], v[44:47], v[60:63]
    buffer_load_dwordx4 v[164:167], v3, s[8:11], s63 offen offset:256 nt
    v_mov_b32_dpp v17, v14 row_newbcast:8 row_mask:0xf bank_mask:0x3
    v_mov_b32_dpp v17, v14 row_newbcast:12 row_mask:0xf bank_mask:0xc
    v_and_b32 v48, v17, v52
    v_and_b32 v49, v17, v53
    v_and_b32 v50, v17, v54
    v_and_b32 v51, v17, v55
    s_waitcnt vmcnt(15)
    s_cbranch_scc1 L_np16
    s_waitcnt vmcnt(5)
L_np16:
    s_nop 0
    v_mfma_f32_16x16x32_bf16 v[56:59], v[168:171], v[48:51], v[56:59]
    buffer_load_dwordx4 v[168:171], v3, s[8:11], s63 offen offset:512 nt
    s_waitcnt vmcnt(15)
    s_cbranch_scc1 L_np17
    s_waitcnt vmcnt(5)
L_np17:
    v_mfma_f32_16x16x32_bf16 v[60:63], v[172:175], v[48:51], v[60:63]
    buffer_load_dwordx4 v[172:175], v3, s[8:11], s63 offen offset:768 nt
    s_branch L_dyn
L_drain0:
    global_load_dword v177, v178, s[96:97]
    s_waitcnt vmcnt(16)
    v_mfma_f32_32x32x16_bf16 v[80:95], v[64:67], v[112:115], 0
    s_waitcnt vmcnt(15)
    v_mfma_f32_32x32x16_bf16 v[80:95], v[68:71], v[116:119], v[80:95]
    s_waitcnt vmcnt(14)
    v_mfma_f32_32x32x16_bf16 v[80:95], v[72:75], v[120:123], v[80:95]
    s_waitcnt vmcnt(13)
    v_mfma_f32_32x32x16_bf16 v[80:95], v[76:79], v[124:127], v[80:95]
    s_nop 11
    v_add_f32_dpp v36, v84, v80 row_shl:4 row_mask:0xf bank_mask:0x5
    v_add_f32_dpp v36, v88, v92 row_shr:4 row_mask:0xf bank_mask:0xa
    v_add_f32_dpp v37, v85, v81 row_shl:4 row_mask:0xf bank_mask:0x5
    v_add_f32_dpp v37, v89, v93 row_shr:4 row_mask:0xf bank_mask:0xa
    v_add_f32_dpp v38, v86, v82 row_shl:4 row_mask:0xf bank_mask:0x5
    v_add_f32_dpp v38, v90, v94 row_shr:4 row_mask:0xf bank_mask:0xa
    v_add_f32_dpp v39, v87, v83 row_shl:4 row_mask:0xf bank_mask:0x5
    v_add_f32_dpp v39, v91, v95 row_shr:4 row_mask:0xf bank_mask:0xa
    s_nop 1
    v_add_f32_dpp v32, v38, v36 quad_perm:[2,3,0,1] row_mask:0xf bank_mask:0xf
    v_add_f32_dpp v33, v39, v37 quad_perm:[2,3,0,1] row_mask:0xf bank_mask:0xf
    s_nop 1
    v_add_f32_dpp v10, v33, v32 quad_perm:[1,0,3,2] row_mask:0xf bank_mask:0xf
    s_nop 1
    v_mov_b32_dpp v8, v10 quad_perm:[0,0,0,0] row_mask:0xf bank_mask:0xf
    v_cvt_pk_bf16_f32 v8, v8, v8
    v_and_b32 v8, 0xffff0000, v8
    v_cmp_gt_f32 vcc, v8, v5
    s_cbranch_vccnz L_rare18
L_back18:
    v_sub_f32 v10, v8, v5
    v_mul_f32 v10, s70, v10
    v_exp_f32 v10, v10
    s_nop 0
    v_cvt_pk_bf16_f32 v14, v10, v10
    v_add_f32 v7, v7, v10
    s_nop 0
    v_mov_b32_dpp v16, v14 row_newbcast:0 row_mask:0xf bank_mask:0x3
    v_mov_b32_dpp v16, v14 row_newbcast:4 row_mask:0xf bank_mask:0xc
    v_and_b32 v44, v16, v52
    v_and_b32 v45, v16, v53
    v_and_b32 v46, v16, v54
    v_and_b32 v47, v16, v55
    s_waitcnt vmcnt(12)
    s_nop 0
    v_mfma_f32_16x16x32_bf16 v[56:59], v[128:131], v[44:47], v[56:59]
    s_waitcnt vmcnt(11)
    v_mfma_f32_16x16x32_bf16 v[60:63], v[132:135], v[44:47], v[60:63]
    v_mov_b32_dpp v17, v14 row_newbcast:8 row_mask:0xf bank_mask:0x3
    v_mov_b32_dpp v17, v14 row_newbcast:12 row_mask:0xf bank_mask:0xc
    v_and_b32 v48, v17, v52
    v_and_b32 v49, v17, v53
    v_and_b32 v50, v17, v54
    v_and_b32 v51, v17, v55
    s_waitcnt vmcnt(10)
    s_nop 0
    v_mfma_f32_16x16x32_bf16 v[56:59], v[136:139], v[48:51], v[56:59]
    s_waitcnt vmcnt(9)
    v_mfma_f32_16x16x32_bf16 v[60:63], v[140:143], v[48:51], v[60:63]
    s_waitcnt vmcnt(8)
    v_mfma_f32_32x32x16_bf16 v[80:95], v[64:67], v[144:147], 0
    s_waitcnt vmcnt(7)
    v_mfma_f32_32x32x16_bf16 v[80:95], v[68:71], v[148:151], v[80:95]
    s_waitcnt vmcnt(6)
    v_mfma_f32_32x32x16_bf16 v[80:95], v[72:75], v[152:155], v[80:95]
    s_waitcnt vmcnt(5)
    v_mfma_f32_32x32x16_bf16 v[80:95], v[76:79], v[156:159], v[80:95]
    s_nop 11
    v_add_f32_dpp v36, v84, v80 row_shl:4 row_mask:0xf bank_mask:0x5
    v_add_f32_dpp v36, v88, v92 row_shr:4 row_mask:0xf bank_mask:0xa
    v_add_f32_dpp v37, v85, v81 row_shl:4 row_mask:0xf bank_mask:0x5
    v_add_f32_dpp v37, v89, v93 row_shr:4 row_mask:0xf bank_mask:0xa
    v_add_f32_dpp v38, v86, v82 row_shl:4 row_mask:0xf bank_mask:0x5
    v_add_f32_dpp v38, v90, v94 row_shr:4 row_mask:0xf bank_mask:0xa
    v_add_f32_dpp v39, v87, v83 row_shl:4 row_mask:0xf bank_mask:0x5
    v_add_f32_dpp v39, v91, v95 row_shr:4 row_mask:0xf bank_mask:0xa
    s_nop 1
    v_add_f32_dpp v32, v38, v36 quad_perm:[2,3,0,1] row_mask:0xf bank_mask:0xf
    v_add_f32_dpp v33, v39, v37 quad_perm:[2,3,0,1] row_mask:0xf bank_mask:0xf
    s_nop 1
    v_add_f32_dpp v10, v33, v32 quad_perm:[1,0,3,2] row_mask:0xf bank_mask:0xf
    s_nop 1
    v_mov_b32_dpp v8, v10 quad_perm:[0,0,0,0] row_mask:0xf bank_mask:0xf
    v_cvt_pk_bf16_f32 v8, v8, v8
    v_and_b32 v8, 0xffff0000, v8
    v_cmp_gt_f32 vcc, v8, v5
    s_cbranch_vccnz L_rare19
L_back19:
    v_sub_f32 v10, v8, v5
    v_mul_f32 v10, s70, v10
    v_exp_f32 v10, v10
    s_nop 0
    v_cvt_pk_bf16_f32 v14, v10, v10
    v_add_f32 v7, v7, v10
    s_nop 0
    v_fmac_f32 v6, 0x3e800000, v7
    s_nop 1
    v_add_f32_dpp v6, v6, v6 quad_perm:[1,0,3,2] row_mask:0xf bank_mask:0xf
    s_nop 1
    v_add_f32_dpp v6, v6, v6 quad_perm:[2,3,0,1] row_mask:0xf bank_mask:0xf
    s_nop 1
    v_add_f32_dpp v6, v6, v6 row_ror:8 row_mask:0xf bank_mask:0xf
    v_mov_b32 v11, v6
    s_nop 1
    v_permlane16_swap_b32 v6, v11
    s_nop 0
    v_add_f32 v6, v6, v11
    v_mov_b32 v11, v6
    s_nop 1
    v_permlane32_swap_b32 v6, v11
    s_nop 0
    v_add_f32 v6, v6, v11
    v_mov_b32 v32, v5
    v_mov_b32 v34, v6
    v_mov_b32 v33, s71
    v_mov_b32 v35, s71
    s_mov_b64 exec, 0x11
    ds_write_b32 v22, v32 offset:0
    buffer_store_dwordx4 v[32:35], v28, s[12:15], s35 offen sc1
    s_mov_b64 exec, -1
    v_mov_b32_dpp v16, v14 row_newbcast:0 row_mask:0xf bank_mask:0x3
    v_mov_b32_dpp v16, v14 row_newbcast:4 row_mask:0xf bank_mask:0xc
    v_and_b32 v44, v16, v52
    v_and_b32 v45, v16, v53
    v_and_b32 v46, v16, v54
    v_and_b32 v47, v16, v55
    s_waitcnt vmcnt(5)
    s_nop 0
    v_mfma_f32_16x16x32_bf16 v[56:59], v[160:163], v[44:47], v[56:59]
    s_waitcnt vmcnt(4)
    v_mfma_f32_16x16x32_bf16 v[60:63], v[164:167], v[44:47], v[60:63]
    v_mov_b32_dpp v17, v14 row_newbcast:8 row_mask:0xf bank_mask:0x3
    v_mov_b32_dpp v17, v14 row_newbcast:12 row_mask:0xf bank_mask:0xc
    v_and_b32 v48, v17, v52
    v_and_b32 v49, v17, v53
    v_and_b32 v50, v17, v54
    v_and_b32 v51, v17, v55
    s_waitcnt vmcnt(3)
    s_nop 0
    v_mfma_f32_16x16x32_bf16 v[56:59], v[168:171], v[48:51], v[56:59]
    s_waitcnt vmcnt(2)
    v_mfma_f32_16x16x32_bf16 v[60:63], v[172:175], v[48:51], v[60:63]
    s_branch L_fin
L_drain1:
    global_load_dword v177, v178, s[96:97]
    s_waitcnt vmcnt(16)
    v_mfma_f32_32x32x16_bf16 v[80:95], v[64:67], v[144:147], 0
    s_waitcnt vmcnt(15)
    v_mfma_f32_32x32x16_bf16 v[80:95], v[68:71], v[148:151], v[80:95]
    s_waitcnt vmcnt(14)
    v_mfma_f32_32x32x16_bf16 v[80:95], v[72:75], v[152:155], v[80:95]
    s_waitcnt vmcnt(13)
    v_mfma_f32_32x32x16_bf16 v[80:95], v[76:79], v[156:159], v[80:95]
    s_nop 11
    v_add_f32_dpp v36, v84, v80 row_shl:4 row_mask:0xf bank_mask:0x5
    v_add_f32_dpp v36, v88, v92 row_shr:4 row_mask:0xf bank_mask:0xa
    v_add_f32_dpp v37, v85, v81 row_shl:4 row_mask:0xf bank_mask:0x5
    v_add_f32_dpp v37, v89, v93 row_shr:4 row_mask:0xf bank_mask:0xa
    v_add_f32_dpp v38, v86, v82 row_shl:4 row_mask:0xf bank_mask:0x5
    v_add_f32_dpp v38, v90, v94 row_shr:4 row_mask:0xf bank_mask:0xa
    v_add_f32_dpp v39, v87, v83 row_shl:4 row_mask:0xf bank_mask:0x5
    v_add_f32_dpp v39, v91, v95 row_shr:4 row_mask:0xf bank_mask:0xa
    s_nop 1
    v_add_f32_dpp v32, v38, v36 quad_perm:[2,3,0,1] row_mask:0xf bank_mask:0xf
    v_add_f32_dpp v33, v39, v37 quad_perm:[2,3,0,1] row_mask:0xf bank_mask:0xf
    s_nop 1
    v_add_f32_dpp v10, v33, v32 quad_perm:[1,0,3,2] row_mask:0xf bank_mask:0xf
    s_nop 1
    v_mov_b32_dpp v8, v10 quad_perm:[0,0,0,0] row_mask:0xf bank_mask:0xf
    v_cvt_pk_bf16_f32 v8, v8, v8
    v_and_b32 v8, 0xffff0000, v8
    v_cmp_gt_f32 vcc, v8, v5
    s_cbranch_vccnz L_rare20
L_back20:
    v_sub_f32 v10, v8, v5
    v_mul_f32 v10, s70, v10
    v_exp_f32 v10, v10
    s_nop 0
    v_cvt_pk_bf16_f32 v14, v10, v10
    v_add_f32 v7, v7, v10
    s_nop 0
    v_mov_b32_dpp v16, v14 row_newbcast:0 row_mask:0xf bank_mask:0x3
    v_mov_b32_dpp v16, v14 row_newbcast:4 row_mask:0xf bank_mask:0xc
    v_and_b32 v44, v16, v52
    v_and_b32 v45, v16, v53
    v_and_b32 v46, v16, v54
    v_and_b32 v47, v16, v55
    s_waitcnt vmcnt(12)
    s_nop 0
    v_mfma_f32_16x16x32_bf16 v[56:59], v[160:163], v[44:47], v[56:59]
    s_waitcnt vmcnt(11)
    v_mfma_f32_16x16x32_bf16 v[60:63], v[164:167], v[44:47], v[60:63]
    v_mov_b32_dpp v17, v14 row_newbcast:8 row_mask:0xf bank_mask:0x3
    v_mov_b32_dpp v17, v14 row_newbcast:12 row_mask:0xf bank_mask:0xc
    v_and_b32 v48, v17, v52
    v_and_b32 v49, v17, v53
    v_and_b32 v50, v17, v54
    v_and_b32 v51, v17, v55
    s_waitcnt vmcnt(10)
    s_nop 0
    v_mfma_f32_16x16x32_bf16 v[56:59], v[168:171], v[48:51], v[56:59]
    s_waitcnt vmcnt(9)
    v_mfma_f32_16x16x32_bf16 v[60:63], v[172:175], v[48:51], v[60:63]
    s_waitcnt vmcnt(8)
    v_mfma_f32_32x32x16_bf16 v[80:95], v[64:67], v[112:115], 0
    s_waitcnt vmcnt(7)
    v_mfma_f32_32x32x16_bf16 v[80:95], v[68:71], v[116:119], v[80:95]
    s_waitcnt vmcnt(6)
    v_mfma_f32_32x32x16_bf16 v[80:95], v[72:75], v[120:123], v[80:95]
    s_waitcnt vmcnt(5)
    v_mfma_f32_32x32x16_bf16 v[80:95], v[76:79], v[124:127], v[80:95]
    s_nop 11
    v_add_f32_dpp v36, v84, v80 row_shl:4 row_mask:0xf bank_mask:0x5
    v_add_f32_dpp v36, v88, v92 row_shr:4 row_mask:0xf bank_mask:0xa
    v_add_f32_dpp v37, v85, v81 row_shl:4 row_mask:0xf bank_mask:0x5
    v_add_f32_dpp v37, v89, v93 row_shr:4 row_mask:0xf bank_mask:0xa
    v_add_f32_dpp v38, v86, v82 row_shl:4 row_mask:0xf bank_mask:0x5
    v_add_f32_dpp v38, v90, v94 row_shr:4 row_mask:0xf bank_mask:0xa
    v_add_f32_dpp v39, v87, v83 row_shl:4 row_mask:0xf bank_mask:0x5
    v_add_f32_dpp v39, v91, v95 row_shr:4 row_mask:0xf bank_mask:0xa
    s_nop 1
    v_add_f32_dpp v32, v38, v36 quad_perm:[2,3,0,1] row_mask:0xf bank_mask:0xf
    v_add_f32_dpp v33, v39, v37 quad_perm:[2,3,0,1] row_mask:0xf bank_mask:0xf
    s_nop 1
    v_add_f32_dpp v10, v33, v32 quad_perm:[1,0,3,2] row_mask:0xf bank_mask:0xf
    s_nop 1
    v_mov_b32_dpp v8, v10 quad_perm:[0,0,0,0] row_mask:0xf bank_mask:0xf
    v_cvt_pk_bf16_f32 v8, v8, v8
    v_and_b32 v8, 0xffff0000, v8
    v_cmp_gt_f32 vcc, v8, v5
    s_cbranch_vccnz L_rare21
L_back21:
    v_sub_f32 v10, v8, v5
    v_mul_f32 v10, s70, v10
    v_exp_f32 v10, v10
    s_nop 0
    v_cvt_pk_bf16_f32 v14, v10, v10
    v_add_f32 v7, v7, v10
    s_nop 0
    v_fmac_f32 v6, 0x3e800000, v7
    s_nop 1
    v_add_f32_dpp v6, v6, v6 quad_perm:[1,0,3,2] row_mask:0xf bank_mask:0xf
    s_nop 1
    v_add_f32_dpp v6, v6, v6 quad_perm:[2,3,0,1] row_mask:0xf bank_mask:0xf
    s_nop 1
    v_add_f32_dpp v6, v6, v6 row_ror:8 row_mask:0xf bank_mask:0xf
    v_mov_b32 v11, v6
    s_nop 1
    v_permlane16_swap_b32 v6, v11
    s_nop 0
    v_add_f32 v6, v6, v11
    v_mov_b32 v11, v6
    s_nop 1
    v_permlane32_swap_b32 v6, v11
    s_nop 0
    v_add_f32 v6, v6, v11
    v_mov_b32 v32, v5
    v_mov_b32 v34, v6
    v_mov_b32 v33, s71
    v_mov_b32 v35, s71
    s_mov_b64 exec, 0x11
    ds_write_b32 v22, v32 offset:0
    buffer_store_dwordx4 v[32:35], v28, s[12:15], s35 offen sc1
    s_mov_b64 exec, -1
    v_mov_b32_dpp v16, v14 row_newbcast:0 row_mask:0xf bank_mask:0x3
    v_mov_b32_dpp v16, v14 row_newbcast:4 row_mask:0xf bank_mask:0xc
    v_and_b32 v44, v16, v52
    v_and_b32 v45, v16, v53
    v_and_b32 v46, v16, v54
    v_and_b32 v47, v16, v55
    s_waitcnt vmcnt(5)
    s_nop 0
    v_mfma_f32_16x16x32_bf16 v[56:59], v[128:131], v[44:47], v[56:59]
    s_waitcnt vmcnt(4)
    v_mfma_f32_16x16x32_bf16 v[60:63], v[132:135], v[44:47], v[60:63]
    v_mov_b32_dpp v17, v14 row_newbcast:8 row_mask:0xf bank_mask:0x3
    v_mov_b32_dpp v17, v14 row_newbcast:12 row_mask:0xf bank_mask:0xc
    v_and_b32 v48, v17, v52
    v_and_b32 v49, v17, v53
    v_and_b32 v50, v17, v54
    v_and_b32 v51, v17, v55
    s_waitcnt vmcnt(3)
    s_nop 0
    v_mfma_f32_16x16x32_bf16 v[56:59], v[136:139], v[48:51], v[56:59]
    s_waitcnt vmcnt(2)
    v_mfma_f32_16x16x32_bf16 v[60:63], v[140:143], v[48:51], v[60:63]
L_fin:
    s_nop 6
    ds_write_b128 v21, v[56:59]
    ds_write_b128 v21, v[60:63] offset:1024
    s_cmp_ge_u32 s3, 2
    s_waitcnt lgkmcnt(0)
    s_barrier
    s_cbranch_scc1 L_pdone
    ds_read_b128 v[80:83], v25 offset:0
    ds_read_b128 v[112:115], v23 offset:2048
    ds_read_b128 v[116:119], v23 offset:6144
    ds_read_b128 v[120:123], v23 offset:10240
    ds_read_b128 v[124:127], v23 offset:14336
    s_waitcnt lgkmcnt(4)
    v_max3_f32 v88, v80, v81, v82
    v_max_f32 v88, v88, v83
    v_sub_f32 v80, v80, v88
    v_sub_f32 v81, v81, v88
    v_sub_f32 v82, v82, v88
    v_sub_f32 v83, v83, v88
    v_mul_f32 v80, s70, v80
    v_mul_f32 v81, s70, v81
    v_mul_f32 v82, s70, v82
    v_mul_f32 v83, s70, v83
    v_exp_f32 v80, v80
    v_exp_f32 v81, v81
    v_exp_f32 v82, v82
    v_exp_f32 v83, v83
    s_waitcnt lgkmcnt(3)
    v_mul_f32 v88, v80, v112
    v_mul_f32 v89, v80, v113
    v_mul_f32 v90, v80, v114
    v_mul_f32 v91, v80, v115
    s_waitcnt lgkmcnt(2)
    v_fmac_f32 v88, v81, v116
    v_fmac_f32 v89, v81, v117
    v_fmac_f32 v90, v81, v118
    v_fmac_f32 v91, v81, v119
    s_waitcnt lgkmcnt(1)
    v_fmac_f32 v88, v82, v120
    v_fmac_f32 v89, v82, v121
    v_fmac_f32 v90, v82, v122
    v_fmac_f32 v91, v82, v123
    s_waitcnt lgkmcnt(0)
    v_fmac_f32 v88, v83, v124
    v_fmac_f32 v89, v83, v125
    v_fmac_f32 v90, v83, v126
    v_fmac_f32 v91, v83, v127
    v_perm_b32 v88, v88, v20, s28
    v_perm_b32 v89, v89, v20, s29
    v_perm_b32 v90, v90, v20, s30
    v_perm_b32 v91, v91, v20, s31
    buffer_store_dwordx4 v[88:91], v24, s[12:15], s34 offen sc1
L_pdone:
    s_cmp_ge_u32 s2, 240
    s_cbranch_scc1 L_done
    s_cmp_ge_u32 s2, 184
    s_cbranch_scc1 L_s3
    s_cmp_ge_u32 s2, 128
    s_cbranch_scc1 L_s2
    v_and_b32 v10, 1, v1
    v_lshlrev_b32 v11, 6, v10
    v_lshrrev_b32 v12, 4, v1
    v_lshl_add_u32 v11, v12, 4, v11
    v_add_u32 v11, 128, v11
    v_bfe_u32 v12, v1, 2, 2
    v_mov_b32 v13, 64
    v_cmp_eq_u32 vcc, 0, v12
    s_nop 1
    v_cndmask_b32 v36, v13, v11, vcc
    v_cmp_eq_u32 vcc, 1, v12
    s_nop 1
    v_cndmask_b32 v37, v13, v11, vcc
    v_cmp_eq_u32 vcc, 2, v12
    s_nop 1
    v_cndmask_b32 v38, v13, v11, vcc
    v_cmp_eq_u32 vcc, 3, v12
    s_nop 1
    v_cndmask_b32 v39, v13, v11, vcc
    v_lshrrev_b32 v11, 2, v1
    s_lshl_b32 s67, s3, 4
    v_add_u32 v11, s67, v11
    v_lshrrev_b32 v12, 0, v11
    v_lshlrev_b32 v12, 14, v12
    v_and_b32 v11, 0, v11
    v_lshl_add_u32 v11, v11, 12, v12
    v_and_b32 v10, 3, v1
    v_lshl_add_u32 v2, v10, 4, v11
    s_cmp_eq_u32 s3, 3
    s_cselect_b32 s36, 0, -1
    s_lshr_b32 s67, s3, 1
    s_and_b32 s68, s3, 1
    s_lshr_b32 s82, s2, 1
    s_lshl_b32 s82, s82, 2
    s_and_b32 s83, s2, 1
    s_add_u32 s82, s82, s83
    s_lshl_b32 s82, s82, 12
    s_lshl_b32 s83, s67, 11
    s_add_u32 s82, s82, s83
    s_lshl_b32 s83, s68, 6
    s_add_u32 s82, s82, s83
    s_add_u32 s82, s82, 262144
    s_add_u32 s82, s82, s51
    s_lshr_b32 s83, s2, 3
    s_lshl_b32 s84, s67, 4
    s_add_u32 s83, s83, s84
    s_and_b32 s84, s83, 24
    s_add_u32 s83, s83, s84
    s_lshl_b32 s83, s83, 10
    s_add_u32 s83, s83, 1310720
    s_add_u32 s83, s83, s51
    v_lshrrev_b32 v9, 2, v1
    v_lshlrev_b32 v9, 7, v9
    v_and_b32 v11, 3, v1
    v_lshl_add_u32 v9, v11, 4, v9
    s_lshl_b32 s67, s67, 6
    s_lshl_b32 s68, s68, 3
    s_add_u32 s67, s67, s68
    v_and_b32 v10, 48, v1
    v_lshl_add_u32 v10, v11, 1, v10
    v_add_u32 v8, s67, v10
    s_lshl_b32 s85, s2, 6
    s_add_u32 s85, s85, 262144
    s_add_u32 s85, s85, s50
L_s1ml:
    buffer_load_dwordx4 v[116:119], v18, s[12:15], s83 offen sc1
    buffer_load_dwordx4 v[112:115], v9, s[12:15], s82 offen sc1
    s_waitcnt vmcnt(1)
    v_cmp_ne_u32 vcc, s71, v117
    v_cmp_ne_u32 s[78:79], s71, v119
    s_or_b64 vcc, vcc, s[78:79]
    s_cbranch_scc0 L_s1w
    s_waitcnt vmcnt(0)
    s_add_u32 s89, s89, 1
    s_cmp_lt_u32 s89, 200000
    s_cbranch_scc1 L_s1ml
    s_branch L_end
L_s1w:
    v_max_f32_dpp v12, v116, v116 quad_perm:[1,0,3,2] row_mask:0xf bank_mask:0xf
    s_nop 1
    v_max_f32_dpp v12, v12, v12 quad_perm:[2,3,0,1] row_mask:0xf bank_mask:0xf
    s_nop 1
    v_max_f32_dpp v10, v12, v12 row_ror:4 row_mask:0xf bank_mask:0xf
    s_nop 1
    v_max_f32_dpp v10, v10, v10 row_ror:8 row_mask:0xf bank_mask:0xf
    v_mov_b32 v11, v10
    s_nop 1
    v_permlane16_swap_b32 v10, v11
    v_max_f32 v10, v10, v11
    v_mov_b32 v11, v10
    s_nop 1
    v_permlane32_swap_b32 v10, v11
    v_max_f32 v10, v10, v11
    v_sub_f32 v11, v116, v10
    v_sub_f32 v12, v12, v10
    v_mul_f32 v11, s70, v11
    v_mul_f32 v12, s70, v12
    v_exp_f32 v11, v11
    v_exp_f32 v12, v12
    v_mul_f32 v11, v11, v118
    s_nop 1
    v_add_f32_dpp v11, v11, v11 quad_perm:[1,0,3,2] row_mask:0xf bank_mask:0xf
    s_nop 1
    v_add_f32_dpp v11, v11, v11 quad_perm:[2,3,0,1] row_mask:0xf bank_mask:0xf
    s_nop 1
    v_add_f32_dpp v11, v11, v11 row_ror:4 row_mask:0xf bank_mask:0xf
    s_nop 1
    v_add_f32_dpp v11, v11, v11 row_ror:8 row_mask:0xf bank_mask:0xf
    v_mov_b32 v10, v11
    s_nop 1
    v_permlane16_swap_b32 v10, v11
    v_add_f32 v10, v10, v11
    v_mov_b32 v11, v10
    s_nop 1
    v_permlane32_swap_b32 v10, v11
    v_add_f32 v10, v10, v11
    v_rcp_f32 v10, v10
    s_nop 0
    v_mul_f32 v12, v12, v10
    s_branch L_s1chk
L_s1poll:
    buffer_load_dwordx4 v[112:115], v9, s[12:15], s82 offen sc1
L_s1chk:
    s_waitcnt vmcnt(0)
    v_perm_b32 v10, v113, v112, s32
    v_perm_b32 v11, v115, v114, s33
    v_or_b32 v10, v10, v11
    v_cmp_ne_u32 vcc, s71, v10
    s_cbranch_vccz L_s1go
    s_add_u32 s89, s89, 1
    s_cmp_lt_u32 s89, 200000
    s_cbranch_scc1 L_s1poll
    s_branch L_end
L_s1go:
    v_mul_f32 v112, v12, v112
    v_mul_f32 v114, v12, v114
    v_mul_f32 v113, v12, v113
    v_mul_f32 v115, v12, v115
    v_permlane32_swap_b32 v112, v114
    s_nop 0
    v_permlane32_swap_b32 v113, v115
    v_add_f32 v112, v112, v114
    v_add_f32 v113, v113, v115
    s_nop 1
    v_permlane16_swap_b32 v112, v113
    v_add_f32 v112, v112, v113
    s_nop 1
    v_add_f32_dpp v112, v112, v112 row_ror:8 row_mask:0xf bank_mask:0xf
    s_nop 1
    v_add_f32_dpp v112, v112, v112 row_ror:4 row_mask:0xf bank_mask:0xf
    v_cvt_pk_bf16_f32 v10, v112, v112
    ds_write_b16 v8, v10 offset:128
    s_waitcnt lgkmcnt(0)
    s_barrier
    ds_read_b128 v[64:67], v36
    ds_read_b128 v[68:71], v37
    ds_read_b128 v[72:75], v38
    ds_read_b128 v[76:79], v39
    s_cmp_eq_u32 s3, 3
    s_waitcnt lgkmcnt(3)
    v_mfma_f32_16x16x32_bf16 v[44:47], v[64:67], a[0:3], 0
    v_mfma_f32_16x16x32_bf16 v[48:51], v[64:67], a[4:7], 0
    s_waitcnt lgkmcnt(2)
    v_mfma_f32_16x16x32_bf16 v[44:47], v[68:71], a[8:11], v[44:47]
    v_mfma_f32_16x16x32_bf16 v[48:51], v[68:71], a[12:15], v[48:51]
    s_cbranch_scc1 L_gskipa
    s_waitcnt lgkmcnt(1)
    v_mfma_f32_16x16x32_bf16 v[44:47], v[72:75], a[16:19], v[44:47]
    v_mfma_f32_16x16x32_bf16 v[48:51], v[72:75], a[20:23], v[48:51]
    s_waitcnt lgkmcnt(0)
    v_mfma_f32_16x16x32_bf16 v[44:47], v[76:79], a[24:27], v[44:47]
    v_mfma_f32_16x16x32_bf16 v[48:51], v[76:79], a[28:31], v[48:51]
L_gskipa:
    s_mov_b32 exec_hi, s36
    s_nop 5
    v_perm_b32 v32, v44, v20, s28
    v_perm_b32 v33, v45, v20, s29
    v_perm_b32 v34, v48, v20, s30
    v_perm_b32 v35, v49, v20, s31
    buffer_store_dwordx4 v[32:35], v2, s[12:15], s85 offen sc1
    s_mov_b64 exec, -1
    s_branch L_done
L_s2:
    s_sub_u32 s64, s2, 128
    s_lshr_b32 s67, s64, 2
    s_lshl_b32 s67, s67, 6
    s_and_b32 s68, s64, 3
    s_lshl_b32 s68, s68, 3
    s_add_u32 s67, s67, s68
    v_bfe_u32 v10, v1, 4, 1
    v_mul_u32_u24 v12, 896, v10
    v_lshrrev_b32 v10, 5, v1
    v_lshl_add_u32 v12, v10, 5, v12
    v_and_b32 v11, 3, v1
    v_lshl_add_u32 v12, v11, 1, v12
    v_add_u32 v3, s67, v12
    buffer_load_ushort v14, v3, s[24:27], 0 offen
    v_lshrrev_b32 v10, 4, v1
    v_lshl_add_u32 v10, v10, 2, v11
    v_lshlrev_b32 v9, 4, v10
    s_lshl_b32 s67, s3, 2
    v_add_u32 v4, s67, v9
    s_lshl_b32 s82, s64, 14
    s_lshl_b32 s67, s3, 11
    s_add_u32 s82, s82, s67
    s_add_u32 s82, s82, 262144
    s_add_u32 s82, s82, s50
    s_lshl_b32 s83, s64, 6
    s_add_u32 s83, s83, 1769472
    s_add_u32 s83, s83, s50
    s_lshr_b32 s84, s64, 1
    s_lshl_b32 s84, s84, 2
    s_and_b32 s67, s64, 1
    s_add_u32 s84, s84, s67
    s_lshl_b32 s84, s84, 12
    s_mul_i32 s67, s3, 896
    s_add_u32 s84, s84, s67
    s_add_u32 s84, s84, 1310720
    s_add_u32 s84, s84, s50
    v_mov_b32 v10, 0
    s_mov_b64 s[24:25], s[40:41]
    v_perm_b32 v120, v10, v20, s28
    v_perm_b32 v121, v10, v20, s29
    v_perm_b32 v122, v10, v20, s30
    v_perm_b32 v123, v10, v20, s31
L_s2poll:
    buffer_load_dwordx4 v[112:115], v18, s[12:15], s82 offen sc1
    buffer_load_dwordx4 v[116:119], v18, s[12:15], s82 offen offset:1024 sc1
    s_waitcnt vmcnt(0)
    v_perm_b32 v10, v113, v112, s32
    v_perm_b32 v11, v115, v114, s33
    v_or_b32 v10, v10, v11
    v_perm_b32 v12, v117, v116, s32
    v_perm_b32 v11, v119, v118, s33
    v_or_b32 v12, v12, v11
    v_cmp_ne_u32 vcc, s71, v10
    v_cmp_ne_u32 s[80:81], s71, v12
    s_or_b64 vcc, vcc, s[80:81]
    s_cbranch_scc0 L_s2go
    s_add_u32 s89, s89, 1
    s_cmp_lt_u32 s89, 200000
    s_cbranch_scc1 L_s2poll
    s_branch L_end
L_s2go:
    v_add_f32 v112, v112, v116
    v_add_f32 v114, v114, v118
    v_add_f32 v113, v113, v117
    v_add_f32 v115, v115, v119
    s_nop 0
    v_permlane32_swap_b32 v112, v114
    v_permlane32_swap_b32 v113, v115
    v_add_f32 v112, v112, v114
    v_add_f32 v113, v113, v115
    s_nop 1
    v_permlane16_swap_b32 v112, v113
    v_add_f32 v112, v112, v113
    s_nop 1
    v_add_f32_dpp v112, v112, v112 row_ror:8 row_mask:0xf bank_mask:0xf
    s_nop 1
    v_add_f32_dpp v112, v112, v112 row_ror:4 row_mask:0xf bank_mask:0xf
    ds_write_b32 v4, v112 offset:768
    s_cmp_lg_u32 s3, 0
    s_waitcnt lgkmcnt(0)
    s_barrier
    s_cbranch_scc1 L_s4poll
    ds_read_b128 v[112:115], v9 offset:768
    v_lshlrev_b32 v14, 16, v14
    v_mov_b32 v34, s71
    v_mov_b32 v35, s71
    s_waitcnt lgkmcnt(0)
    v_add_f32 v10, v112, v113
    v_add_f32 v11, v114, v115
    v_add_f32 v10, v10, v11
    v_cvt_pk_bf16_f32 v10, v10, v10
    v_and_b32 v10, 0xffff0000, v10
    v_add_f32 v10, v10, v14
    v_cvt_pk_bf16_f32 v10, v10, v10
    v_and_b32 v5, 0xffff0000, v10
    s_nop 0
    v_mov_b32_dpp v11, v10 quad_perm:[1,1,3,3] row_mask:0xf bank_mask:0xf
    v_alignbit_b32 v32, v11, v10, 16
    s_nop 1
    v_mov_b32_dpp v33, v32 quad_perm:[2,2,2,2] row_mask:0xf bank_mask:0xf
    s_mov_b32 exec_lo, 0x10001
    s_mov_b32 exec_hi, 0x10001
    buffer_store_dwordx4 v[32:35], v1, s[12:15], s83 offen sc1
    s_mov_b64 exec, -1
L_s4poll:
    s_mov_b32 exec_hi, 0xffffff
    buffer_load_dwordx4 v[120:123], v18, s[12:15], s84 offen sc1
    s_mov_b64 exec, -1
    s_waitcnt vmcnt(0)
    v_perm_b32 v10, v121, v120, s32
    v_perm_b32 v11, v123, v122, s33
    v_or_b32 v10, v10, v11
    v_cmp_ne_u32 vcc, s71, v10
    s_cbranch_vccz L_s4go
    s_add_u32 s89, s89, 1
    s_cmp_lt_u32 s89, 200000
    s_cbranch_scc1 L_s4poll
    s_branch L_end
L_s4go:
    v_permlane32_swap_b32 v120, v122
    v_permlane32_swap_b32 v121, v123
    v_add_f32 v120, v120, v122
    v_add_f32 v121, v121, v123
    s_nop 1
    v_permlane16_swap_b32 v120, v121
    v_add_f32 v120, v120, v121
    s_nop 1
    v_add_f32_dpp v120, v120, v120 row_ror:8 row_mask:0xf bank_mask:0xf
    s_nop 1
    v_add_f32_dpp v120, v120, v120 row_ror:4 row_mask:0xf bank_mask:0xf
    ds_write_b32 v4, v120 offset:256
    s_cmp_lg_u32 s3, 0
    s_waitcnt lgkmcnt(0)
    s_barrier
    s_cbranch_scc1 L_done
    ds_read_b128 v[112:115], v9 offset:256
    s_waitcnt lgkmcnt(0)
    v_add_f32 v10, v112, v113
    v_add_f32 v11, v114, v115
    v_add_f32 v10, v10, v11
    v_cvt_pk_bf16_f32 v10, v10, v10
    v_and_b32 v10, 0xffff0000, v10
    v_add_f32 v10, v10, v5
    v_cvt_pk_bf16_f32 v10, v10, v10
    s_mov_b32 exec_lo, 0xf000f
    s_mov_b32 exec_hi, 0xf000f
    buffer_store_short v10, v3, s[24:27], 0 offen
    s_mov_b64 exec, -1
    s_cmp_lg_u32 s2, 128
    s_cbranch_scc1 L_done
    v_mov_b32 v11, 0
    s_mov_b64 exec, 1
    buffer_store_dword v20, v11, s[12:15], 0 offen
    s_mov_b64 exec, -1
    s_branch L_done
L_s3:
    s_mul_i32 s67, s3, 7168
    s_add_u32 m0, s67, 47104
    s_nop 0
    buffer_load_dwordx4 v19, s[20:23], s92 offen nt lds
    s_add_u32 m0, s67, 48128
    s_add_u32 s92, s92, 57344
    buffer_load_dwordx4 v19, s[20:23], s92 offen nt lds
    s_add_u32 m0, s67, 49152
    s_add_u32 s92, s92, 57344
    buffer_load_dwordx4 v19, s[20:23], s92 offen nt lds
    s_add_u32 m0, s67, 50176
    s_add_u32 s92, s92, 57344
    buffer_load_dwordx4 v19, s[20:23], s92 offen nt lds
    s_add_u32 m0, s67, 51200
    s_add_u32 s92, s92, 57344
    buffer_load_dwordx4 v19, s[20:23], s92 offen nt lds
    s_add_u32 m0, s67, 52224
    s_add_u32 s92, s92, 57344
    buffer_load_dwordx4 v19, s[20:23], s92 offen nt lds
    s_add_u32 m0, s67, 53248
    s_add_u32 s92, s92, 57344
    buffer_load_dwordx4 v19, s[20:23], s92 offen nt lds
    s_waitcnt vmcnt(0)
    s_barrier
    ds_read_b64_tr_b16 a[32:33], v27 offset:47104
    ds_read_b64_tr_b16 a[34:35], v27 offset:47360
    ds_read_b64_tr_b16 a[36:37], v27 offset:49152
    ds_read_b64_tr_b16 a[38:39], v27 offset:49408
    ds_read_b64_tr_b16 a[40:41], v27 offset:51200
    ds_read_b64_tr_b16 a[42:43], v27 offset:51456
    ds_read_b64_tr_b16 a[44:45], v27 offset:53248
    ds_read_b64_tr_b16 a[46:47], v27 offset:53504
    ds_read_b64_tr_b16 a[48:49], v27 offset:55296
    ds_read_b64_tr_b16 a[50:51], v27 offset:55552
    ds_read_b64_tr_b16 a[52:53], v27 offset:57344
    ds_read_b64_tr_b16 a[54:55], v27 offset:57600
    ds_read_b64_tr_b16 a[56:57], v27 offset:59392
    ds_read_b64_tr_b16 a[58:59], v27 offset:59648
    s_waitcnt lgkmcnt(0)
    s_lshl_b32 s90, s3, 12
    s_add_u32 s90, s90, 4096
    v_and_b32 v10, 1, v1
    v_lshlrev_b32 v11, 6, v10
    v_lshrrev_b32 v12, 4, v1
    v_lshl_add_u32 v11, v12, 4, v11
    v_add_u32 v11, s90, v11
    v_bfe_u32 v12, v1, 2, 2
    v_mov_b32 v13, 64
    v_cmp_eq_u32 vcc, 0, v12
    s_nop 1
    v_cndmask_b32 v36, v13, v11, vcc
    v_cmp_eq_u32 vcc, 1, v12
    s_nop 1
    v_cndmask_b32 v37, v13, v11, vcc
    v_cmp_eq_u32 vcc, 2, v12
    s_nop 1
    v_cndmask_b32 v38, v13, v11, vcc
    v_cmp_eq_u32 vcc, 3, v12
    s_nop 1
    v_cndmask_b32 v39, v13, v11, vcc
    v_lshrrev_b32 v11, 2, v1
    s_lshl_b32 s67, s3, 4
    v_add_u32 v11, s67, v11
    v_lshrrev_b32 v12, 1, v11
    v_lshlrev_b32 v12, 14, v12
    v_and_b32 v11, 1, v11
    v_lshl_add_u32 v11, v11, 12, v12
    v_and_b32 v10, 3, v1
    v_lshl_add_u32 v2, v10, 4, v11
    s_cmp_eq_u32 s3, 3
    s_cselect_b32 s36, 0, -1
    v_mov_b32 v80, 0x3f803f80
    v_mov_b32 v81, 0x3f803f80
    v_mov_b32 v82, 0x3f803f80
    v_mov_b32 v83, 0x3f803f80
    v_lshl_add_u32 v6, v1, 1, s90
    s_lshl_b32 s92, s42, 6
    s_add_u32 s92, s92, 1310720
    s_add_u32 s92, s92, s50
    v_mfma_f32_16x16x32_bf16 v[56:59], v[80:83], a[32:35], 0
    v_mfma_f32_16x16x32_bf16 v[56:59], v[80:83], a[36:39], v[56:59]
    v_mfma_f32_16x16x32_bf16 v[56:59], v[80:83], a[40:43], v[56:59]
    v_mfma_f32_16x16x32_bf16 v[56:59], v[80:83], a[44:47], v[56:59]
    v_mfma_f32_16x16x32_bf16 v[56:59], v[80:83], a[48:51], v[56:59]
    v_mfma_f32_16x16x32_bf16 v[56:59], v[80:83], a[52:55], v[56:59]
    v_mfma_f32_16x16x32_bf16 v[56:59], v[80:83], a[56:59], v[56:59]
    s_and_b32 s67, s3, 1
    s_lshl_b32 s67, s67, 6
    s_lshr_b32 s68, s3, 1
    s_lshl_b32 s91, s68, 8
    s_add_u32 s67, s67, s91
    v_bfe_u32 v10, v1, 4, 1
    v_lshlrev_b32 v12, 7, v10
    v_and_b32 v11, 15, v1
    v_lshl_add_u32 v12, v11, 2, v12
    v_add_u32 v8, s67, v12
    v_lshlrev_b32 v7, 5, v10
    v_and_b32 v11, 1, v1
    v_lshl_add_u32 v10, v11, 1, v10
    s_lshl_b32 s67, s3, 2
    v_lshl_add_u32 v14, v10, 4, s67
    v_mul_u32_u24 v11, 896, v11
    v_lshrrev_b32 v10, 4, v1
    v_lshl_add_u32 v10, v10, 4, v11
    s_mul_i32 s68, s68, 448
    v_add_u32 v4, s68, v10
    s_mul_i32 s67, s3, 56
    v_add_u32 v10, s67, v1
    v_lshrrev_b32 v12, 4, v10
    v_lshl_add_u32 v11, v12, 6, v11
    v_bfe_u32 v12, v10, 1, 1
    v_lshl_add_u32 v11, v12, 5, v11
    v_bfe_u32 v12, v10, 2, 2
    v_lshl_add_u32 v9, v12, 3, v11
    s_mul_i32 s91, s3, 896
    s_add_u32 s91, s91, 1769472
    s_add_u32 s91, s91, s50
    v_mov_b32 v120, 0
    v_mov_b32 v121, 0
    v_mov_b32 v122, s71
L_s3poll:
    s_mov_b32 exec_hi, 0xffffff
    buffer_load_dwordx4 v[120:123], v18, s[12:15], s91 offen sc1
    s_mov_b64 exec, -1
    s_waitcnt vmcnt(0)
    v_cmp_ne_u32 vcc, s71, v122
    s_cbranch_vccz L_s3go
    s_add_u32 s89, s89, 1
    s_cmp_lt_u32 s89, 200000
    s_cbranch_scc1 L_s3poll
    s_branch L_end
L_s3go:
    s_mov_b32 exec_hi, 0xffffff
    ds_write_b64 v9, v[120:121] offset:4352
    s_mov_b64 exec, -1
    v_lshlrev_b32 v112, 16, v120
    v_and_b32 v113, 0xffff0000, v120
    v_lshlrev_b32 v114, 16, v121
    v_and_b32 v115, 0xffff0000, v121
    v_add_f32 v10, v112, v113
    v_mul_f32 v11, v112, v112
    v_add_f32 v12, v114, v115
    v_fmac_f32 v11, v113, v113
    v_add_f32 v10, v10, v12
    v_fmac_f32 v11, v114, v114
    v_fmac_f32 v11, v115, v115
    v_add_f32_dpp v10, v10, v10 quad_perm:[2,3,0,1] row_mask:0xf bank_mask:0xf
    s_nop 0
    v_add_f32_dpp v11, v11, v11 quad_perm:[2,3,0,1] row_mask:0xf bank_mask:0xf
    v_add_f32_dpp v10, v10, v10 row_ror:4 row_mask:0xf bank_mask:0xf
    s_nop 0
    v_add_f32_dpp v11, v11, v11 row_ror:4 row_mask:0xf bank_mask:0xf
    v_add_f32_dpp v10, v10, v10 row_ror:8 row_mask:0xf bank_mask:0xf
    s_nop 0
    v_add_f32_dpp v11, v11, v11 row_ror:8 row_mask:0xf bank_mask:0xf
    s_nop 1
    v_permlane16_swap_b32 v10, v11
    v_add_f32 v10, v10, v11
    v_mov_b32 v11, v10
    s_nop 1
    v_permlane32_swap_b32 v10, v11
    v_add_f32 v10, v10, v11
    ds_write_b32 v14, v10 offset:1024
    s_waitcnt lgkmcnt(0)
    s_barrier
    ds_read_b128 v[112:115], v7 offset:1024
    ds_read_b128 v[116:119], v7 offset:1040
    ds_read_b128 v[80:83], v4 offset:4352
    ds_read_b128 v[84:87], v4 offset:4416
    ds_read_b128 v[88:91], v4 offset:4480
    ds_read_b128 v[92:95], v4 offset:4544
    ds_read_b128 v[96:99], v4 offset:4608
    ds_read_b128 v[100:103], v4 offset:4672
    ds_read_b128 v[104:107], v4 offset:4736
    s_waitcnt lgkmcnt(6)
    v_mfma_f32_16x16x32_bf16 v[44:47], v[80:83], a[32:35], 0
    v_add_f32 v10, v112, v113
    v_add_f32 v11, v116, v117
    v_add_f32 v12, v114, v115
    s_waitcnt lgkmcnt(5)
    v_mfma_f32_16x16x32_bf16 v[44:47], v[84:87], a[36:39], v[44:47]
    v_add_f32 v13, v118, v119
    v_add_f32 v10, v10, v12
    v_add_f32 v11, v11, v13
    s_waitcnt lgkmcnt(4)
    v_mfma_f32_16x16x32_bf16 v[44:47], v[88:91], a[40:43], v[44:47]
    v_mul_f32 v10, 0x3b124925, v10
    v_mul_f32 v11, 0x3b124925, v11
    v_fma_f32 v11, -v10, v10, v11
    s_waitcnt lgkmcnt(3)
    v_mfma_f32_16x16x32_bf16 v[44:47], v[92:95], a[44:47], v[44:47]
    v_max_f32 v11, 0, v11
    v_cvt_pk_bf16_f32 v10, v10, v11
    v_and_b32 v11, 0xffff0000, v10
    s_waitcnt lgkmcnt(2)
    v_mfma_f32_16x16x32_bf16 v[44:47], v[96:99], a[48:51], v[44:47]
    v_lshlrev_b32 v10, 16, v10
    v_add_f32 v11, 0x3727c5ac, v11
    s_waitcnt lgkmcnt(1)
    v_mfma_f32_16x16x32_bf16 v[44:47], v[100:103], a[52:55], v[44:47]
    v_cvt_pk_bf16_f32 v11, v11, v11
    v_and_b32 v11, 0xffff0000, v11
    s_waitcnt lgkmcnt(0)
    v_mfma_f32_16x16x32_bf16 v[44:47], v[104:107], a[56:59], v[44:47]
    v_sqrt_f32 v11, v11
    v_mul_f32 v10, v10, v56
    v_cvt_pk_bf16_f32 v11, v11, v11
    v_and_b32 v11, 0xffff0000, v11
    v_rcp_f32 v11, v11
    s_nop 2
    v_mov_b32_dpp v44, v45 quad_perm:[0,1,2,3] row_mask:0xa bank_mask:0xf
    v_lshlrev_b32 v12, 2, v1
    v_sub_f32 v10, v44, v10
    v_mul_f32 v10, v10, v11
    ds_write_b32 v8, v10 offset:256
    s_waitcnt lgkmcnt(0)
    s_barrier
    ds_read2_b32 v[16:17], v12 offset0:64 offset1:128
    s_waitcnt lgkmcnt(0)
    v_add_f32 v10, v16, v17
    v_cvt_pk_bf16_f32 v10, v10, v10
    v_and_b32 v10, 0xffff0000, v10
    v_mul_f32 v11, 0xbfb8aa3b, v10
    v_exp_f32 v11, v11
    s_nop 0
    v_add_f32 v11, 1.0, v11
    v_rcp_f32 v11, v11
    s_nop 0
    v_mul_f32 v10, v10, v11
    v_cvt_pk_bf16_f32 v10, v10, v10
    ds_write_b16 v6, v10
    ds_read_b128 v[64:67], v36
    ds_read_b128 v[68:71], v37
    ds_read_b128 v[72:75], v38
    ds_read_b128 v[76:79], v39
    s_cmp_eq_u32 s3, 3
    s_waitcnt lgkmcnt(3)
    v_mfma_f32_16x16x32_bf16 v[44:47], v[64:67], a[0:3], 0
    v_mfma_f32_16x16x32_bf16 v[48:51], v[64:67], a[4:7], 0
    s_waitcnt lgkmcnt(2)
    v_mfma_f32_16x16x32_bf16 v[44:47], v[68:71], a[8:11], v[44:47]
    v_mfma_f32_16x16x32_bf16 v[48:51], v[68:71], a[12:15], v[48:51]
    s_cbranch_scc1 L_gskipb
    s_waitcnt lgkmcnt(1)
    v_mfma_f32_16x16x32_bf16 v[44:47], v[72:75], a[16:19], v[44:47]
    v_mfma_f32_16x16x32_bf16 v[48:51], v[72:75], a[20:23], v[48:51]
    s_waitcnt lgkmcnt(0)
    v_mfma_f32_16x16x32_bf16 v[44:47], v[76:79], a[24:27], v[44:47]
    v_mfma_f32_16x16x32_bf16 v[48:51], v[76:79], a[28:31], v[48:51]
L_gskipb:
    s_mov_b32 exec_hi, s36
    s_nop 5
    v_perm_b32 v32, v44, v20, s28
    v_perm_b32 v33, v45, v20, s29
    v_perm_b32 v34, v48, v20, s30
    v_perm_b32 v35, v49, v20, s31
    buffer_store_dwordx4 v[32:35], v2, s[12:15], s92 offen sc1
    s_mov_b64 exec, -1
L_done:
L_end:
    s_endpgm
L_sprod:
    s_mov_b32 s18, 3670016
    v_lshrrev_b32 v12, 3, v1
    v_and_b32 v13, 7, v1
    v_and_b32 v10, 2, v12
    v_xor_b32 v13, v13, v10
    v_lshlrev_b32 v12, 13, v12
    v_lshl_add_u32 v12, v13, 4, v12
    v_xor_b32 v13, 64, v12
    s_mul_i32 s67, s3, 917504
    s_lshl_b32 s68, s64, 7
    s_add_u32 s67, s67, s68
    s_mul_i32 s68, s3, 14336
    s_waitcnt lgkmcnt(0)
    s_mov_b64 s[16:17], s[28:29]
    s_add_u32 m0, s68, 18432
    s_nop 0
    buffer_load_dwordx4 v12, s[16:19], s67 offen nt lds
    s_add_u32 m0, s68, 19456
    s_add_u32 s67, s67, 65536
    buffer_load_dwordx4 v13, s[16:19], s67 offen nt lds
    s_add_u32 m0, s68, 20480
    s_add_u32 s67, s67, 65536
    buffer_load_dwordx4 v12, s[16:19], s67 offen nt lds
    s_add_u32 m0, s68, 21504
    s_add_u32 s67, s67, 65536
    buffer_load_dwordx4 v13, s[16:19], s67 offen nt lds
    s_add_u32 m0, s68, 22528
    s_add_u32 s67, s67, 65536
    buffer_load_dwordx4 v12, s[16:19], s67 offen nt lds
    s_add_u32 m0, s68, 23552
    s_add_u32 s67, s67, 65536
    buffer_load_dwordx4 v13, s[16:19], s67 offen nt lds
    s_add_u32 m0, s68, 24576
    s_add_u32 s67, s67, 65536
    buffer_load_dwordx4 v12, s[16:19], s67 offen nt lds
    s_add_u32 m0, s68, 25600
    s_add_u32 s67, s67, 65536
    buffer_load_dwordx4 v13, s[16:19], s67 offen nt lds
    s_add_u32 m0, s68, 26624
    s_add_u32 s67, s67, 65536
    buffer_load_dwordx4 v12, s[16:19], s67 offen nt lds
    s_add_u32 m0, s68, 27648
    s_add_u32 s67, s67, 65536
    buffer_load_dwordx4 v13, s[16:19], s67 offen nt lds
    s_add_u32 m0, s68, 28672
    s_add_u32 s67, s67, 65536
    buffer_load_dwordx4 v12, s[16:19], s67 offen nt lds
    s_add_u32 m0, s68, 29696
    s_add_u32 s67, s67, 65536
    buffer_load_dwordx4 v13, s[16:19], s67 offen nt lds
    s_add_u32 m0, s68, 30720
    s_add_u32 s67, s67, 65536
    buffer_load_dwordx4 v12, s[16:19], s67 offen nt lds
    s_add_u32 m0, s68, 31744
    s_add_u32 s67, s67, 65536
    buffer_load_dwordx4 v13, s[16:19], s67 offen nt lds
    s_waitcnt vmcnt(4)
    buffer_load_dwordx4 v[112:115], v2, s[4:7], s52 offen offset:0 nt
    s_waitcnt vmcnt(4)
    buffer_load_dwordx4 v[116:119], v2, s[4:7], s52 offen offset:256 nt
    s_waitcnt vmcnt(4)
    buffer_load_dwordx4 v[120:123], v2, s[4:7], s52 offen offset:2048 nt
    s_waitcnt vmcnt(4)
    buffer_load_dwordx4 v[124:127], v2, s[4:7], s52 offen offset:2304 nt
    s_waitcnt vmcnt(4)
    s_barrier
    buffer_load_dwordx4 v[128:131], v2, s[4:7], s53 offen offset:0 nt
    s_branch L_sjoin
L_helper:
    s_mov_b32 s89, 0
    v_lshlrev_b32 v8, 5, v1
    s_lshl_b32 s90, s65, 11
    s_add_u32 s90, s90, 32768
    s_waitcnt lgkmcnt(0)
    s_load_dword s71, s[12:13], 0
    s_cmp_lt_u32 s64, 64
    s_cbranch_scc1 L_prod
    s_waitcnt lgkmcnt(0)
    s_mul_i32 s71, s71, 1664525
    s_add_u32 s71, s71, 1013904223
    s_sub_u32 s68, s2, 184
    s_cmp_ge_u32 s68, 48
    s_cbranch_scc1 L_noprod
    s_mov_b32 s82, 0
    s_mov_b32 s84, 0
    s_and_b32 s85, s68, 15
    s_and_b32 s67, s85, 7
    s_lshl3_add_u32 s67, s85, s67
    s_lshl_b32 s67, s67, 21
    s_add_u32 s67, s67, 1835008
    s_cmp_lt_u32 s68, 16
    s_cselect_b32 s86, s4, s8
    s_cselect_b32 s87, s5, s9
    s_cmp_lt_u32 s68, 32
    s_cbranch_scc1 L_race0
    s_lshl_b32 s67, s85, 14
    s_add_u32 s67, s67, 1835008
    s_mov_b32 s85, 0
    s_mov_b64 s[86:87], s[12:13]
    v_bfe_u32 v10, v1, 2, 1
    v_lshlrev_b32 v10, 13, v10
    v_and_b32 v11, 3, v1
    v_mul_u32_u24 v11, 1280, v11
    v_lshrrev_b32 v12, 3, v1
    v_lshlrev_b32 v12, 7, v12
    v_add3_u32 v10, v10, v11, v12
    v_mov_b32 v11, 0
    s_mov_b64 exec, 0xffffff
    buffer_store_dword v11, v10, s[12:15], s67 offen sc1
    s_mov_b64 exec, -1
    s_waitcnt vmcnt(0)
L_race0:
    s_add_u32 s86, s86, s67
    s_addc_u32 s87, s87, 0
L_race:
    s_mov_b32 s24, -1
    s_mov_b32 s25, -1
    s_mov_b32 s26, -1
    s_mov_b32 s27, -1
    s_mov_b32 s16, -1
    s_mov_b32 s17, -1
    s_mov_b32 s18, -1
    s_mov_b32 s19, -1
    s_load_dword s24, s[86:87], 0
    s_load_dword s16, s[86:87], 8192
    s_load_dword s17, s[86:87], 9472
    s_load_dword s25, s[86:87], 1280
    s_load_dword s26, s[86:87], 2560
    s_load_dword s18, s[86:87], 10752
    s_load_dword s19, s[86:87], 12032
    s_load_dword s27, s[86:87], 3840
    s_waitcnt lgkmcnt(5)
    s_cmp_lg_u32 s16, -1
    s_addc_u32 s82, s82, 0
    s_cmp_lg_u32 s24, -1
    s_subb_u32 s82, s82, 0
    s_cmp_lg_u32 s17, -1
    s_addc_u32 s82, s82, 0
    s_cmp_lg_u32 s25, -1
    s_subb_u32 s82, s82, 0
    s_cmp_lg_u32 s18, -1
    s_addc_u32 s82, s82, 0
    s_cmp_lg_u32 s26, -1
    s_subb_u32 s82, s82, 0
    s_cmp_lg_u32 s19, -1
    s_addc_u32 s82, s82, 0
    s_cmp_lg_u32 s27, -1
    s_subb_u32 s82, s82, 0
    s_add_u32 s86, s86, 128
    s_addc_u32 s87, s87, 0
    s_add_u32 s84, s84, 1
    s_cmp_lt_u32 s84, 3
    s_waitcnt lgkmcnt(0)
    s_cbranch_scc1 L_race
    s_sub_u32 s83, 0, s82
    s_bitcmp1_b32 s85, 0
    s_cselect_b32 s82, s83, s82
    v_mov_b32 v16, s82
    v_mov_b32 v17, s71
    s_lshl_b32 s68, s68, 3
    v_mov_b32 v10, s68
    s_mov_b64 exec, 1
    buffer_store_dwordx2 v[16:17], v10, s[12:15], 0 offen offset:2048 sc1
    s_mov_b64 exec, -1
    s_branch L_noprod
L_prod:
    v_mov_b32 v11, 0x10000
    v_cmp_gt_u32 vcc, 56, v1
    s_lshr_b32 s67, s64, 3
    s_bfe_u32 s68, s64, 0x10002
    v_cndmask_b32 v11, v11, v18, vcc
    buffer_load_dwordx4 v[96:99], v11, s[24:27], 0 offen
    buffer_load_dwordx4 v[100:103], v11, s[24:27], 0 offen offset:896
    s_lshl_b32 s68, s68, 3
    s_add_u32 s67, s67, s68
    s_lshl_b32 s67, s67, 2
    s_and_b32 s68, s64, 3
    s_add_u32 s67, s67, s68
    s_lshl_b32 s67, s67, 8
    s_add_u32 s67, s67, 4096
    v_mov_b32 v10, 0
    s_mov_b64 exec, 1
    buffer_store_dword v10, v10, s[12:15], s67 offen sc1
    s_mov_b64 exec, -1
    s_waitcnt vmcnt(1)
    v_lshlrev_b32 v80, 16, v96
    v_and_b32 v81, 0xffff0000, v96
    v_lshlrev_b32 v82, 16, v97
    v_and_b32 v83, 0xffff0000, v97
    v_lshlrev_b32 v84, 16, v98
    v_and_b32 v85, 0xffff0000, v98
    v_lshlrev_b32 v86, 16, v99
    v_and_b32 v87, 0xffff0000, v99
    v_lshlrev_b32 v88, 16, v100
    v_and_b32 v89, 0xffff0000, v100
    v_lshlrev_b32 v90, 16, v101
    v_and_b32 v91, 0xffff0000, v101
    v_lshlrev_b32 v92, 16, v102
    v_and_b32 v93, 0xffff0000, v102
    v_lshlrev_b32 v94, 16, v103
    v_and_b32 v95, 0xffff0000, v103
    v_add_f32 v32, v80, v81
    v_mul_f32 v34, v80, v80
    v_add_f32 v33, v88, v89
    v_mul_f32 v35, v88, v88
    v_fmac_f32 v34, v81, v81
    v_fmac_f32 v35, v89, v89
    v_add_f32 v32, v32, v82
    v_fmac_f32 v34, v82, v82
    v_add_f32 v33, v33, v90
    v_fmac_f32 v35, v90, v90
    v_add_f32 v32, v32, v83
    v_fmac_f32 v34, v83, v83
    v_add_f32 v33, v33, v91
    v_fmac_f32 v35, v91, v91
    v_add_f32 v32, v32, v84
    v_fmac_f32 v34, v84, v84
    v_add_f32 v33, v33, v92
    v_fmac_f32 v35, v92, v92
    v_add_f32 v32, v32, v85
    v_fmac_f32 v34, v85, v85
    v_add_f32 v33, v33, v93
    v_fmac_f32 v35, v93, v93
    v_add_f32 v32, v32, v86
    v_fmac_f32 v34, v86, v86
    v_add_f32 v33, v33, v94
    v_fmac_f32 v35, v94, v94
    v_add_f32 v32, v32, v87
    v_fmac_f32 v34, v87, v87
    v_add_f32 v33, v33, v95
    v_fmac_f32 v35, v95, v95
    s_nop 0
    v_add_f32_dpp v32, v32, v32 quad_perm:[1,0,3,2] row_mask:0xf bank_mask:0xf
    v_add_f32_dpp v33, v33, v33 quad_perm:[1,0,3,2] row_mask:0xf bank_mask:0xf
    v_add_f32_dpp v34, v34, v34 quad_perm:[1,0,3,2] row_mask:0xf bank_mask:0xf
    v_add_f32_dpp v35, v35, v35 quad_perm:[1,0,3,2] row_mask:0xf bank_mask:0xf
    v_add_f32_dpp v32, v32, v32 quad_perm:[2,3,0,1] row_mask:0xf bank_mask:0xf
    v_add_f32_dpp v33, v33, v33 quad_perm:[2,3,0,1] row_mask:0xf bank_mask:0xf
    v_add_f32_dpp v34, v34, v34 quad_perm:[2,3,0,1] row_mask:0xf bank_mask:0xf
    v_add_f32_dpp v35, v35, v35 quad_perm:[2,3,0,1] row_mask:0xf bank_mask:0xf
    v_add_f32_dpp v32, v32, v32 row_ror:4 row_mask:0xf bank_mask:0xf
    v_add_f32_dpp v33, v33, v33 row_ror:4 row_mask:0xf bank_mask:0xf
    v_add_f32_dpp v34, v34, v34 row_ror:4 row_mask:0xf bank_mask:0xf
    v_add_f32_dpp v35, v35, v35 row_ror:4 row_mask:0xf bank_mask:0xf
    v_add_f32_dpp v32, v32, v32 row_ror:8 row_mask:0xf bank_mask:0xf
    v_add_f32_dpp v33, v33, v33 row_ror:8 row_mask:0xf bank_mask:0xf
    v_add_f32_dpp v34, v34, v34 row_ror:8 row_mask:0xf bank_mask:0xf
    v_add_f32_dpp v35, v35, v35 row_ror:8 row_mask:0xf bank_mask:0xf
    v_permlane16_swap_b32 v32, v33
    s_nop 0
    v_permlane16_swap_b32 v34, v35
    v_add_f32 v32, v32, v33
    v_add_f32 v34, v34, v35
    s_nop 1
    v_permlane32_swap_b32 v32, v34
    s_nop 0
    v_add_f32 v32, v32, v34
    v_mul_f32 v32, 0x3b124925, v32
    v_mov_b32 v34, v32
    s_nop 1
    v_permlane32_swap_b32 v32, v34
    s_nop 0
    v_fma_f32 v34, -v32, v32, v34
    v_max_f32 v34, 0, v34
    v_cvt_pk_bf16_f32 v32, v32, v34
    v_and_b32 v34, 0xffff0000, v32
    v_lshlrev_b32 v32, 16, v32
    v_add_f32 v34, 0x3727c5ac, v34
    v_cvt_pk_bf16_f32 v34, v34, v34
    v_and_b32 v34, 0xffff0000, v34
    v_sqrt_f32 v34, v34
    v_readlane_b32 s82, v32, 0
    v_cvt_pk_bf16_f32 v34, v34, v34
    v_readlane_b32 s83, v32, 16
    v_and_b32 v34, 0xffff0000, v34
    v_rcp_f32 v34, v34
    v_subrev_f32 v80, s82, v80
    v_subrev_f32 v81, s82, v81
    v_subrev_f32 v82, s82, v82
    v_subrev_f32 v83, s82, v83
    v_subrev_f32 v84, s82, v84
    v_subrev_f32 v85, s82, v85
    v_subrev_f32 v86, s82, v86
    v_subrev_f32 v87, s82, v87
    v_readlane_b32 s84, v34, 0
    v_readlane_b32 s85, v34, 16
    v_subrev_f32 v88, s83, v88
    v_subrev_f32 v89, s83, v89
    v_subrev_f32 v90, s83, v90
    v_subrev_f32 v91, s83, v91
    v_subrev_f32 v92, s83, v92
    v_subrev_f32 v93, s83, v93
    v_subrev_f32 v94, s83, v94
    v_subrev_f32 v95, s83, v95
    v_cvt_pk_bf16_f32 v80, v80, v81
    v_and_b32 v81, 0xffff0000, v80
    v_lshlrev_b32 v80, 16, v80
    v_mul_f32 v81, s84, v81
    v_mul_f32 v80, s84, v80
    v_cvt_pk_bf16_f32 v80, v80, v81
    v_cvt_pk_bf16_f32 v82, v82, v83
    v_and_b32 v83, 0xffff0000, v82
    v_lshlrev_b32 v82, 16, v82
    v_mul_f32 v83, s84, v83
    v_mul_f32 v82, s84, v82
    v_cvt_pk_bf16_f32 v81, v82, v83
    v_cvt_pk_bf16_f32 v84, v84, v85
    v_and_b32 v85, 0xffff0000, v84
    v_lshlrev_b32 v84, 16, v84
    v_mul_f32 v85, s84, v85
    v_mul_f32 v84, s84, v84
    v_cvt_pk_bf16_f32 v82, v84, v85
    v_cvt_pk_bf16_f32 v86, v86, v87
    v_and_b32 v87, 0xffff0000, v86
    v_lshlrev_b32 v86, 16, v86
    v_mul_f32 v87, s84, v87
    v_mul_f32 v86, s84, v86
    v_cvt_pk_bf16_f32 v83, v86, v87
    v_cvt_pk_bf16_f32 v88, v88, v89
    v_and_b32 v89, 0xffff0000, v88
    v_lshlrev_b32 v88, 16, v88
    v_mul_f32 v89, s85, v89
    v_mul_f32 v88, s85, v88
    v_cvt_pk_bf16_f32 v88, v88, v89
    v_cvt_pk_bf16_f32 v90, v90, v91
    v_and_b32 v91, 0xffff0000, v90
    v_lshlrev_b32 v90, 16, v90
    v_mul_f32 v91, s85, v91
    v_mul_f32 v90, s85, v90
    v_cvt_pk_bf16_f32 v89, v90, v91
    v_cvt_pk_bf16_f32 v92, v92, v93
    v_and_b32 v93, 0xffff0000, v92
    v_lshlrev_b32 v92, 16, v92
    v_mul_f32 v93, s85, v93
    v_mul_f32 v92, s85, v92
    v_cvt_pk_bf16_f32 v90, v92, v93
    v_cvt_pk_bf16_f32 v94, v94, v95
    v_and_b32 v95, 0xffff0000, v94
    v_lshlrev_b32 v94, 16, v94
    v_mul_f32 v95, s85, v95
    v_mul_f32 v94, s85, v94
    v_cvt_pk_bf16_f32 v91, v94, v95
    s_mov_b32 s67, 16384
    v_add_u32 v32, s67, v18
    s_mov_b32 exec_hi, 0xffffff
    ds_write_b128 v32, v[80:83]
    ds_write_b128 v32, v[88:91] offset:896
    s_mov_b64 exec, -1
    v_and_b32 v33, 1, v1
    v_mul_u32_u24 v33, 896, v33
    v_lshrrev_b32 v34, 4, v1
    v_lshl_add_u32 v33, v34, 4, v33
    v_add_u32 v33, s67, v33
    s_waitcnt lgkmcnt(0)
    ds_read_b128 v[112:115], v33 offset:0
    ds_read_b128 v[116:119], v33 offset:64
    ds_read_b128 v[120:123], v33 offset:128
    ds_read_b128 v[124:127], v33 offset:192
    ds_read_b128 v[128:131], v33 offset:256
    ds_read_b128 v[132:135], v33 offset:320
    ds_read_b128 v[136:139], v33 offset:384
    ds_read_b128 v[140:143], v33 offset:448
    ds_read_b128 v[144:147], v33 offset:512
    ds_read_b128 v[148:151], v33 offset:576
    ds_read_b128 v[152:155], v33 offset:640
    ds_read_b128 v[156:159], v33 offset:704
    ds_read_b128 v[160:163], v33 offset:768
    ds_read_b128 v[164:167], v33 offset:832
    s_mul_i32 s71, s71, 1664525
    s_add_u32 s71, s71, 1013904223
    v_lshrrev_b32 v10, 4, v1
    v_bfe_u32 v11, v1, 2, 2
    v_lshl_add_u32 v12, v10, 3, v11
    v_lshlrev_b32 v12, 7, v12
    v_and_b32 v11, 2, v11
    v_and_b32 v10, 1, v10
    v_lshl_or_b32 v11, v10, 2, v11
    v_bfe_u32 v10, v1, 1, 1
    v_xor_b32 v10, v10, v11
    v_lshl_add_u32 v12, v10, 4, v12
    v_and_b32 v10, 1, v1
    v_lshl_add_u32 v12, v10, 3, v12
    v_add_u32 v36, 18432, v12
    v_xor_b32 v37, 32, v36
    v_xor_b32 v38, 64, v36
    v_xor_b32 v39, 96, v36
    v_lshlrev_b32 v10, 14, v10
    v_lshrrev_b32 v11, 1, v1
    v_lshl_add_u32 v10, v11, 3, v10
    s_lshl_b32 s67, s64, 8
    s_add_u32 s67, s67, 32768
    v_mov_b32 v17, s71
    s_mov_b32 s74, 0xaaaaaaaa
    s_mov_b32 s75, 0xaaaaaaaa
    s_waitcnt vmcnt(0)
    s_barrier
    ds_read_b64_tr_b16 a[0:1], v36 offset:0
    ds_read_b64_tr_b16 a[2:3], v36 offset:512
    ds_read_b64_tr_b16 a[4:5], v37 offset:0
    ds_read_b64_tr_b16 a[6:7], v37 offset:512
    ds_read_b64_tr_b16 a[8:9], v38 offset:0
    ds_read_b64_tr_b16 a[10:11], v38 offset:512
    ds_read_b64_tr_b16 a[12:13], v39 offset:0
    ds_read_b64_tr_b16 a[14:15], v39 offset:512
    ds_read_b64_tr_b16 a[16:17], v36 offset:4096
    ds_read_b64_tr_b16 a[18:19], v36 offset:4608
    ds_read_b64_tr_b16 a[20:21], v37 offset:4096
    ds_read_b64_tr_b16 a[22:23], v37 offset:4608
    ds_read_b64_tr_b16 a[24:25], v38 offset:4096
    ds_read_b64_tr_b16 a[26:27], v38 offset:4608
    ds_read_b64_tr_b16 a[28:29], v39 offset:4096
    ds_read_b64_tr_b16 a[30:31], v39 offset:4608
    s_waitcnt lgkmcnt(8)
    v_mfma_f32_16x16x32_bf16 v[64:67], v[112:115], a[0:3], 0
    v_mfma_f32_16x16x32_bf16 v[68:71], v[112:115], a[4:7], 0
    v_mfma_f32_16x16x32_bf16 v[72:75], v[112:115], a[8:11], 0
    v_mfma_f32_16x16x32_bf16 v[76:79], v[112:115], a[12:15], 0
    ds_read_b64_tr_b16 a[32:33], v36 offset:8192
    ds_read_b64_tr_b16 a[34:35], v36 offset:8704
    ds_read_b64_tr_b16 a[36:37], v37 offset:8192
    ds_read_b64_tr_b16 a[38:39], v37 offset:8704
    ds_read_b64_tr_b16 a[40:41], v38 offset:8192
    ds_read_b64_tr_b16 a[42:43], v38 offset:8704
    ds_read_b64_tr_b16 a[44:45], v39 offset:8192
    ds_read_b64_tr_b16 a[46:47], v39 offset:8704
    s_waitcnt lgkmcnt(8)
    v_mfma_f32_16x16x32_bf16 v[64:67], v[116:119], a[16:19], v[64:67]
    v_mfma_f32_16x16x32_bf16 v[68:71], v[116:119], a[20:23], v[68:71]
    v_mfma_f32_16x16x32_bf16 v[72:75], v[116:119], a[24:27], v[72:75]
    v_mfma_f32_16x16x32_bf16 v[76:79], v[116:119], a[28:31], v[76:79]
    ds_read_b64_tr_b16 a[48:49], v36 offset:12288
    ds_read_b64_tr_b16 a[50:51], v36 offset:12800
    ds_read_b64_tr_b16 a[52:53], v37 offset:12288
    ds_read_b64_tr_b16 a[54:55], v37 offset:12800
    ds_read_b64_tr_b16 a[56:57], v38 offset:12288
    ds_read_b64_tr_b16 a[58:59], v38 offset:12800
    ds_read_b64_tr_b16 a[60:61], v39 offset:12288
    ds_read_b64_tr_b16 a[62:63], v39 offset:12800
    s_waitcnt lgkmcnt(8)
    v_mfma_f32_16x16x32_bf16 v[64:67], v[120:123], a[32:35], v[64:67]
    v_mfma_f32_16x16x32_bf16 v[68:71], v[120:123], a[36:39], v[68:71]
    v_mfma_f32_16x16x32_bf16 v[72:75], v[120:123], a[40:43], v[72:75]
    v_mfma_f32_16x16x32_bf16 v[76:79], v[120:123], a[44:47], v[76:79]
    ds_read_b64_tr_b16 a[0:1], v36 offset:16384
    ds_read_b64_tr_b16 a[2:3], v36 offset:16896
    ds_read_b64_tr_b16 a[4:5], v37 offset:16384
    ds_read_b64_tr_b16 a[6:7], v37 offset:16896
    ds_read_b64_tr_b16 a[8:9], v38 offset:16384
    ds_read_b64_tr_b16 a[10:11], v38 offset:16896
    ds_read_b64_tr_b16 a[12:13], v39 offset:16384
    ds_read_b64_tr_b16 a[14:15], v39 offset:16896
    s_waitcnt lgkmcnt(8)
    v_mfma_f32_16x16x32_bf16 v[64:67], v[124:127], a[48:51], v[64:67]
    v_mfma_f32_16x16x32_bf16 v[68:71], v[124:127], a[52:55], v[68:71]
    v_mfma_f32_16x16x32_bf16 v[72:75], v[124:127], a[56:59], v[72:75]
    v_mfma_f32_16x16x32_bf16 v[76:79], v[124:127], a[60:63], v[76:79]
    ds_read_b64_tr_b16 a[16:17], v36 offset:20480
    ds_read_b64_tr_b16 a[18:19], v36 offset:20992
    ds_read_b64_tr_b16 a[20:21], v37 offset:20480
    ds_read_b64_tr_b16 a[22:23], v37 offset:20992
    ds_read_b64_tr_b16 a[24:25], v38 offset:20480
    ds_read_b64_tr_b16 a[26:27], v38 offset:20992
    ds_read_b64_tr_b16 a[28:29], v39 offset:20480
    ds_read_b64_tr_b16 a[30:31], v39 offset:20992
    s_waitcnt lgkmcnt(8)
    v_mfma_f32_16x16x32_bf16 v[64:67], v[128:131], a[0:3], v[64:67]
    v_mfma_f32_16x16x32_bf16 v[68:71], v[128:131], a[4:7], v[68:71]
    v_mfma_f32_16x16x32_bf16 v[72:75], v[128:131], a[8:11], v[72:75]
    v_mfma_f32_16x16x32_bf16 v[76:79], v[128:131], a[12:15], v[76:79]
    ds_read_b64_tr_b16 a[32:33], v36 offset:24576
    ds_read_b64_tr_b16 a[34:35], v36 offset:25088
    ds_read_b64_tr_b16 a[36:37], v37 offset:24576
    ds_read_b64_tr_b16 a[38:39], v37 offset:25088
    ds_read_b64_tr_b16 a[40:41], v38 offset:24576
    ds_read_b64_tr_b16 a[42:43], v38 offset:25088
    ds_read_b64_tr_b16 a[44:45], v39 offset:24576
    ds_read_b64_tr_b16 a[46:47], v39 offset:25088
    s_waitcnt lgkmcnt(8)
    v_mfma_f32_16x16x32_bf16 v[64:67], v[132:135], a[16:19], v[64:67]
    v_mfma_f32_16x16x32_bf16 v[68:71], v[132:135], a[20:23], v[68:71]
    v_mfma_f32_16x16x32_bf16 v[72:75], v[132:135], a[24:27], v[72:75]
    v_mfma_f32_16x16x32_bf16 v[76:79], v[132:135], a[28:31], v[76:79]
    ds_read_b64_tr_b16 a[48:49], v36 offset:28672
    ds_read_b64_tr_b16 a[50:51], v36 offset:29184
    ds_read_b64_tr_b16 a[52:53], v37 offset:28672
    ds_read_b64_tr_b16 a[54:55], v37 offset:29184
    ds_read_b64_tr_b16 a[56:57], v38 offset:28672
    ds_read_b64_tr_b16 a[58:59], v38 offset:29184
    ds_read_b64_tr_b16 a[60:61], v39 offset:28672
    ds_read_b64_tr_b16 a[62:63], v39 offset:29184
    s_waitcnt lgkmcnt(8)
    v_mfma_f32_16x16x32_bf16 v[64:67], v[136:139], a[32:35], v[64:67]
    v_mfma_f32_16x16x32_bf16 v[68:71], v[136:139], a[36:39], v[68:71]
    v_mfma_f32_16x16x32_bf16 v[72:75], v[136:139], a[40:43], v[72:75]
    v_mfma_f32_16x16x32_bf16 v[76:79], v[136:139], a[44:47], v[76:79]
    ds_read_b64_tr_b16 a[0:1], v36 offset:32768
    ds_read_b64_tr_b16 a[2:3], v36 offset:33280
    ds_read_b64_tr_b16 a[4:5], v37 offset:32768
    ds_read_b64_tr_b16 a[6:7], v37 offset:33280
    ds_read_b64_tr_b16 a[8:9], v38 offset:32768
    ds_read_b64_tr_b16 a[10:11], v38 offset:33280
    ds_read_b64_tr_b16 a[12:13], v39 offset:32768
    ds_read_b64_tr_b16 a[14:15], v39 offset:33280
    s_waitcnt lgkmcnt(8)
    v_mfma_f32_16x16x32_bf16 v[64:67], v[140:143], a[48:51], v[64:67]
    v_mfma_f32_16x16x32_bf16 v[68:71], v[140:143], a[52:55], v[68:71]
    v_mfma_f32_16x16x32_bf16 v[72:75], v[140:143], a[56:59], v[72:75]
    v_mfma_f32_16x16x32_bf16 v[76:79], v[140:143], a[60:63], v[76:79]
    ds_read_b64_tr_b16 a[16:17], v36 offset:36864
    ds_read_b64_tr_b16 a[18:19], v36 offset:37376
    ds_read_b64_tr_b16 a[20:21], v37 offset:36864
    ds_read_b64_tr_b16 a[22:23], v37 offset:37376
    ds_read_b64_tr_b16 a[24:25], v38 offset:36864
    ds_read_b64_tr_b16 a[26:27], v38 offset:37376
    ds_read_b64_tr_b16 a[28:29], v39 offset:36864
    ds_read_b64_tr_b16 a[30:31], v39 offset:37376
    s_waitcnt lgkmcnt(8)
    v_mfma_f32_16x16x32_bf16 v[64:67], v[144:147], a[0:3], v[64:67]
    v_mfma_f32_16x16x32_bf16 v[68:71], v[144:147], a[4:7], v[68:71]
    v_mfma_f32_16x16x32_bf16 v[72:75], v[144:147], a[8:11], v[72:75]
    v_mfma_f32_16x16x32_bf16 v[76:79], v[144:147], a[12:15], v[76:79]
    ds_read_b64_tr_b16 a[32:33], v36 offset:40960
    ds_read_b64_tr_b16 a[34:35], v36 offset:41472
    ds_read_b64_tr_b16 a[36:37], v37 offset:40960
    ds_read_b64_tr_b16 a[38:39], v37 offset:41472
    ds_read_b64_tr_b16 a[40:41], v38 offset:40960
    ds_read_b64_tr_b16 a[42:43], v38 offset:41472
    ds_read_b64_tr_b16 a[44:45], v39 offset:40960
    ds_read_b64_tr_b16 a[46:47], v39 offset:41472
    s_waitcnt lgkmcnt(8)
    v_mfma_f32_16x16x32_bf16 v[64:67], v[148:151], a[16:19], v[64:67]
    v_mfma_f32_16x16x32_bf16 v[68:71], v[148:151], a[20:23], v[68:71]
    v_mfma_f32_16x16x32_bf16 v[72:75], v[148:151], a[24:27], v[72:75]
    v_mfma_f32_16x16x32_bf16 v[76:79], v[148:151], a[28:31], v[76:79]
    ds_read_b64_tr_b16 a[48:49], v36 offset:45056
    ds_read_b64_tr_b16 a[50:51], v36 offset:45568
    ds_read_b64_tr_b16 a[52:53], v37 offset:45056
    ds_read_b64_tr_b16 a[54:55], v37 offset:45568
    ds_read_b64_tr_b16 a[56:57], v38 offset:45056
    ds_read_b64_tr_b16 a[58:59], v38 offset:45568
    ds_read_b64_tr_b16 a[60:61], v39 offset:45056
    ds_read_b64_tr_b16 a[62:63], v39 offset:45568
    s_waitcnt lgkmcnt(8)
    v_mfma_f32_16x16x32_bf16 v[64:67], v[152:155], a[32:35], v[64:67]
    v_mfma_f32_16x16x32_bf16 v[68:71], v[152:155], a[36:39], v[68:71]
    v_mfma_f32_16x16x32_bf16 v[72:75], v[152:155], a[40:43], v[72:75]
    v_mfma_f32_16x16x32_bf16 v[76:79], v[152:155], a[44:47], v[76:79]
    ds_read_b64_tr_b16 a[0:1], v36 offset:49152
    ds_read_b64_tr_b16 a[2:3], v36 offset:49664
    ds_read_b64_tr_b16 a[4:5], v37 offset:49152
    ds_read_b64_tr_b16 a[6:7], v37 offset:49664
    ds_read_b64_tr_b16 a[8:9], v38 offset:49152
    ds_read_b64_tr_b16 a[10:11], v38 offset:49664
    ds_read_b64_tr_b16 a[12:13], v39 offset:49152
    ds_read_b64_tr_b16 a[14:15], v39 offset:49664
    s_waitcnt lgkmcnt(8)
    v_mfma_f32_16x16x32_bf16 v[64:67], v[156:159], a[48:51], v[64:67]
    v_mfma_f32_16x16x32_bf16 v[68:71], v[156:159], a[52:55], v[68:71]
    v_mfma_f32_16x16x32_bf16 v[72:75], v[156:159], a[56:59], v[72:75]
    v_mfma_f32_16x16x32_bf16 v[76:79], v[156:159], a[60:63], v[76:79]
    ds_read_b64_tr_b16 a[16:17], v36 offset:53248
    ds_read_b64_tr_b16 a[18:19], v36 offset:53760
    ds_read_b64_tr_b16 a[20:21], v37 offset:53248
    ds_read_b64_tr_b16 a[22:23], v37 offset:53760
    ds_read_b64_tr_b16 a[24:25], v38 offset:53248
    ds_read_b64_tr_b16 a[26:27], v38 offset:53760
    ds_read_b64_tr_b16 a[28:29], v39 offset:53248
    ds_read_b64_tr_b16 a[30:31], v39 offset:53760
    s_waitcnt lgkmcnt(8)
    v_mfma_f32_16x16x32_bf16 v[64:67], v[160:163], a[0:3], v[64:67]
    v_mfma_f32_16x16x32_bf16 v[68:71], v[160:163], a[4:7], v[68:71]
    v_mfma_f32_16x16x32_bf16 v[72:75], v[160:163], a[8:11], v[72:75]
    v_mfma_f32_16x16x32_bf16 v[76:79], v[160:163], a[12:15], v[76:79]
    s_waitcnt lgkmcnt(0)
    v_mfma_f32_16x16x32_bf16 v[64:67], v[164:167], a[16:19], v[64:67]
    v_mfma_f32_16x16x32_bf16 v[68:71], v[164:167], a[20:23], v[68:71]
    v_mfma_f32_16x16x32_bf16 v[72:75], v[164:167], a[24:27], v[72:75]
    v_mfma_f32_16x16x32_bf16 v[76:79], v[164:167], a[28:31], v[76:79]
    s_nop 4
    v_mov_b32_dpp v44, v64 quad_perm:[0,1,2,3] row_mask:0x1 bank_mask:0xf
    v_mov_b32_dpp v45, v65 quad_perm:[0,1,2,3] row_mask:0x1 bank_mask:0xf
    v_mov_b32_dpp v44, v68 quad_perm:[0,1,2,3] row_mask:0x2 bank_mask:0xf
    v_mov_b32_dpp v45, v69 quad_perm:[0,1,2,3] row_mask:0x2 bank_mask:0xf
    v_mov_b32_dpp v44, v72 quad_perm:[0,1,2,3] row_mask:0x4 bank_mask:0xf
    v_mov_b32_dpp v45, v73 quad_perm:[0,1,2,3] row_mask:0x4 bank_mask:0xf
    v_mov_b32_dpp v44, v76 quad_perm:[0,1,2,3] row_mask:0x8 bank_mask:0xf
    v_mov_b32_dpp v45, v77 quad_perm:[0,1,2,3] row_mask:0x8 bank_mask:0xf
    s_nop 0
    v_mov_b32_dpp v46, v44 quad_perm:[1,1,3,3] row_mask:0xf bank_mask:0xf
    v_mov_b32_dpp v47, v45 quad_perm:[1,1,3,3] row_mask:0xf bank_mask:0xf
    v_cvt_pk_bf16_f32 v44, v44, v46
    v_cvt_pk_bf16_f32 v45, v45, v47
    s_nop 1
    v_mov_b32_dpp v46, v45 quad_perm:[0,0,2,2] row_mask:0xf bank_mask:0xf
    v_cndmask_b32 v16, v44, v46, s[74:75]
    buffer_store_dwordx2 v[16:17], v10, s[12:15], s67 offen sc1
L_noprod:
    v_min_u32 v12, 47, v1
    v_lshlrev_b32 v12, 3, v12
    s_barrier
L_q3:
    buffer_load_dwordx2 v[88:89], v12, s[12:15], 0 offen offset:2048 sc1
    buffer_load_dwordx4 v[80:83], v8, s[12:15], s90 offen sc1
    buffer_load_dwordx4 v[84:87], v8, s[12:15], s90 offen offset:16 sc1
    s_waitcnt vmcnt(0)
    v_cmp_ne_u32 vcc, s71, v81
    v_cmp_ne_u32 s[80:81], s71, v83
    s_or_b64 vcc, vcc, s[80:81]
    v_cmp_ne_u32 s[78:79], s71, v85
    s_or_b64 vcc, vcc, s[78:79]
    v_cmp_ne_u32 s[80:81], s71, v87
    s_or_b64 vcc, vcc, s[80:81]
    v_cmp_ne_u32 s[78:79], s71, v89
    s_or_b64 vcc, vcc, s[78:79]
    s_cbranch_scc0 L_q2
    s_add_u32 s89, s89, 1
    s_cmp_lt_u32 s89, 200000
    s_cbranch_scc1 L_q3
    s_branch L_end
L_q2:
    v_add_u32_dpp v10, v88, v88 quad_perm:[1,0,3,2] row_mask:0xf bank_mask:0xf
    v_mov_b32 v81, v82
    v_mov_b32 v82, v84
    v_add_u32_dpp v10, v10, v10 quad_perm:[2,3,0,1] row_mask:0xf bank_mask:0xf
    v_mov_b32 v83, v86
    ds_write_b128 v18, v[80:83] offset:1024
    v_add_u32_dpp v10, v10, v10 row_ror:4 row_mask:0xf bank_mask:0xf
    s_nop 1
    v_add_u32_dpp v10, v10, v10 row_ror:8 row_mask:0xf bank_mask:0xf
    s_waitcnt lgkmcnt(0)
    v_readlane_b32 s82, v10, 0
    v_readlane_b32 s83, v10, 16
    v_readlane_b32 s84, v10, 32
    s_cmp_gt_i32 s82, 0
    s_cselect_b32 s67, 1, 0
    s_cmp_gt_i32 s83, 0
    s_cselect_b32 s68, 2, 0
    s_or_b32 s67, s67, s68
    s_cmp_gt_i32 s84, 0
    s_cselect_b32 s68, 4, 0
    s_or_b32 s67, s67, s68
    s_abs_i32 s82, s82
    s_abs_i32 s83, s83
    s_min_u32 s82, s82, s83
    s_cmp_ge_u32 s82, 12
    s_cselect_b32 s68, 8, 0
    s_bitcmp1_b32 0x99, s67
    s_cselect_b32 s68, s68, 0
    s_or_b32 s67, s67, s68
    v_mov_b32 v10, s67
    v_mov_b32 v11, 0
    ds_write_b32 v11, v10 offset:80
    s_waitcnt lgkmcnt(0)
    s_barrier
    s_branch L_done
L_side:
    s_cmp_lt_u32 s93, 1
    s_cbranch_scc1 L_sideback
    ds_read_b64_tr_b16 a[0:1], v26 offset:18432
    ds_read_b64_tr_b16 a[2:3], v26 offset:22016
    ds_read_b64_tr_b16 a[4:5], v26 offset:18464
    ds_read_b64_tr_b16 a[6:7], v26 offset:22048
    ds_read_b64_tr_b16 a[8:9], v26 offset:18496
    ds_read_b64_tr_b16 a[10:11], v26 offset:22080
    ds_read_b64_tr_b16 a[12:13], v26 offset:18528
    ds_read_b64_tr_b16 a[14:15], v26 offset:22112
    ds_read_b64_tr_b16 a[16:17], v26 offset:18560
    ds_read_b64_tr_b16 a[18:19], v26 offset:22144
    ds_read_b64_tr_b16 a[20:21], v26 offset:18592
    ds_read_b64_tr_b16 a[22:23], v26 offset:22176
    ds_read_b64_tr_b16 a[24:25], v26 offset:18624
    ds_read_b64_tr_b16 a[26:27], v26 offset:22208
    ds_read_b64_tr_b16 a[28:29], v26 offset:18656
    ds_read_b64_tr_b16 a[30:31], v26 offset:22240
    s_branch L_sideback
L_rare4:
    v_max_f32 v10, v8, v5
    s_nop 1
    v_max_f32_dpp v10, v10, v10 quad_perm:[1,0,3,2] row_mask:0xf bank_mask:0xf
    s_nop 1
    v_max_f32_dpp v10, v10, v10 quad_perm:[2,3,0,1] row_mask:0xf bank_mask:0xf
    s_nop 1
    v_max_f32_dpp v10, v10, v10 row_ror:8 row_mask:0xf bank_mask:0xf
    v_mov_b32 v11, v10
    s_nop 1
    v_permlane16_swap_b32 v10, v11
    s_nop 0
    v_max_f32 v10, v10, v11
    v_mov_b32 v11, v10
    s_nop 1
    v_permlane32_swap_b32 v10, v11
    s_nop 0
    v_max_f32 v10, v10, v11
    v_sub_f32 v11, v5, v10
    v_mov_b32 v5, v10
    v_mul_f32 v11, s70, v11
    v_exp_f32 v11, v11
    s_nop 1
    v_mul_f32 v6, v6, v11
    v_mul_f32 v7, v7, v11
    v_readlane_b32 s82, v11, 0
    v_readlane_b32 s83, v11, 4
    s_nop 1
    v_mov_b32 v10, s82
    v_mov_b32 v11, s83
    v_cndmask_b32 v10, v10, v11, s[76:77]
    s_nop 7
    v_mul_f32 v56, v56, v10
    v_mul_f32 v57, v57, v10
    v_mul_f32 v58, v58, v10
    v_mul_f32 v59, v59, v10
    v_mul_f32 v60, v60, v10
    v_mul_f32 v61, v61, v10
    v_mul_f32 v62, v62, v10
    v_mul_f32 v63, v63, v10
    s_branch L_back4
L_rare13:
    v_max_f32 v10, v8, v5
    s_nop 1
    v_max_f32_dpp v10, v10, v10 quad_perm:[1,0,3,2] row_mask:0xf bank_mask:0xf
    s_nop 1
    v_max_f32_dpp v10, v10, v10 quad_perm:[2,3,0,1] row_mask:0xf bank_mask:0xf
    s_nop 1
    v_max_f32_dpp v10, v10, v10 row_ror:8 row_mask:0xf bank_mask:0xf
    v_mov_b32 v11, v10
    s_nop 1
    v_permlane16_swap_b32 v10, v11
    s_nop 0
    v_max_f32 v10, v10, v11
    v_mov_b32 v11, v10
    s_nop 1
    v_permlane32_swap_b32 v10, v11
    s_nop 0
    v_max_f32 v10, v10, v11
    v_sub_f32 v11, v5, v10
    v_mov_b32 v5, v10
    v_mul_f32 v11, s70, v11
    v_exp_f32 v11, v11
    s_nop 1
    v_mul_f32 v6, v6, v11
    v_mul_f32 v7, v7, v11
    v_readlane_b32 s82, v11, 0
    v_readlane_b32 s83, v11, 4
    s_nop 1
    v_mov_b32 v10, s82
    v_mov_b32 v11, s83
    v_cndmask_b32 v10, v10, v11, s[76:77]
    s_nop 7
    v_mul_f32 v56, v56, v10
    v_mul_f32 v57, v57, v10
    v_mul_f32 v58, v58, v10
    v_mul_f32 v59, v59, v10
    v_mul_f32 v60, v60, v10
    v_mul_f32 v61, v61, v10
    v_mul_f32 v62, v62, v10
    v_mul_f32 v63, v63, v10
    s_branch L_back13
L_rare18:
    v_max_f32 v10, v8, v5
    s_nop 1
    v_max_f32_dpp v10, v10, v10 quad_perm:[1,0,3,2] row_mask:0xf bank_mask:0xf
    s_nop 1
    v_max_f32_dpp v10, v10, v10 quad_perm:[2,3,0,1] row_mask:0xf bank_mask:0xf
    s_nop 1
    v_max_f32_dpp v10, v10, v10 row_ror:8 row_mask:0xf bank_mask:0xf
    v_mov_b32 v11, v10
    s_nop 1
    v_permlane16_swap_b32 v10, v11
    s_nop 0
    v_max_f32 v10, v10, v11
    v_mov_b32 v11, v10
    s_nop 1
    v_permlane32_swap_b32 v10, v11
    s_nop 0
    v_max_f32 v10, v10, v11
    v_sub_f32 v11, v5, v10
    v_mov_b32 v5, v10
    v_mul_f32 v11, s70, v11
    v_exp_f32 v11, v11
    s_nop 1
    v_mul_f32 v6, v6, v11
    v_mul_f32 v7, v7, v11
    v_readlane_b32 s82, v11, 0
    v_readlane_b32 s83, v11, 4
    s_nop 1
    v_mov_b32 v10, s82
    v_mov_b32 v11, s83
    v_cndmask_b32 v10, v10, v11, s[76:77]
    s_nop 7
    v_mul_f32 v56, v56, v10
    v_mul_f32 v57, v57, v10
    v_mul_f32 v58, v58, v10
    v_mul_f32 v59, v59, v10
    v_mul_f32 v60, v60, v10
    v_mul_f32 v61, v61, v10
    v_mul_f32 v62, v62, v10
    v_mul_f32 v63, v63, v10
    s_branch L_back18
L_rare19:
    v_max_f32 v10, v8, v5
    s_nop 1
    v_max_f32_dpp v10, v10, v10 quad_perm:[1,0,3,2] row_mask:0xf bank_mask:0xf
    s_nop 1
    v_max_f32_dpp v10, v10, v10 quad_perm:[2,3,0,1] row_mask:0xf bank_mask:0xf
    s_nop 1
    v_max_f32_dpp v10, v10, v10 row_ror:8 row_mask:0xf bank_mask:0xf
    v_mov_b32 v11, v10
    s_nop 1
    v_permlane16_swap_b32 v10, v11
    s_nop 0
    v_max_f32 v10, v10, v11
    v_mov_b32 v11, v10
    s_nop 1
    v_permlane32_swap_b32 v10, v11
    s_nop 0
    v_max_f32 v10, v10, v11
    v_sub_f32 v11, v5, v10
    v_mov_b32 v5, v10
    v_mul_f32 v11, s70, v11
    v_exp_f32 v11, v11
    s_nop 1
    v_mul_f32 v6, v6, v11
    v_mul_f32 v7, v7, v11
    v_readlane_b32 s82, v11, 0
    v_readlane_b32 s83, v11, 4
    s_nop 1
    v_mov_b32 v10, s82
    v_mov_b32 v11, s83
    v_cndmask_b32 v10, v10, v11, s[76:77]
    s_nop 7
    v_mul_f32 v56, v56, v10
    v_mul_f32 v57, v57, v10
    v_mul_f32 v58, v58, v10
    v_mul_f32 v59, v59, v10
    v_mul_f32 v60, v60, v10
    v_mul_f32 v61, v61, v10
    v_mul_f32 v62, v62, v10
    v_mul_f32 v63, v63, v10
    s_branch L_back19
L_rare20:
    v_max_f32 v10, v8, v5
    s_nop 1
    v_max_f32_dpp v10, v10, v10 quad_perm:[1,0,3,2] row_mask:0xf bank_mask:0xf
    s_nop 1
    v_max_f32_dpp v10, v10, v10 quad_perm:[2,3,0,1] row_mask:0xf bank_mask:0xf
    s_nop 1
    v_max_f32_dpp v10, v10, v10 row_ror:8 row_mask:0xf bank_mask:0xf
    v_mov_b32 v11, v10
    s_nop 1
    v_permlane16_swap_b32 v10, v11
    s_nop 0
    v_max_f32 v10, v10, v11
    v_mov_b32 v11, v10
    s_nop 1
    v_permlane32_swap_b32 v10, v11
    s_nop 0
    v_max_f32 v10, v10, v11
    v_sub_f32 v11, v5, v10
    v_mov_b32 v5, v10
    v_mul_f32 v11, s70, v11
    v_exp_f32 v11, v11
    s_nop 1
    v_mul_f32 v6, v6, v11
    v_mul_f32 v7, v7, v11
    v_readlane_b32 s82, v11, 0
    v_readlane_b32 s83, v11, 4
    s_nop 1
    v_mov_b32 v10, s82
    v_mov_b32 v11, s83
    v_cndmask_b32 v10, v10, v11, s[76:77]
    s_nop 7
    v_mul_f32 v56, v56, v10
    v_mul_f32 v57, v57, v10
    v_mul_f32 v58, v58, v10
    v_mul_f32 v59, v59, v10
    v_mul_f32 v60, v60, v10
    v_mul_f32 v61, v61, v10
    v_mul_f32 v62, v62, v10
    v_mul_f32 v63, v63, v10
    s_branch L_back20
L_rare21:
    v_max_f32 v10, v8, v5
    s_nop 1
    v_max_f32_dpp v10, v10, v10 quad_perm:[1,0,3,2] row_mask:0xf bank_mask:0xf
    s_nop 1
    v_max_f32_dpp v10, v10, v10 quad_perm:[2,3,0,1] row_mask:0xf bank_mask:0xf
    s_nop 1
    v_max_f32_dpp v10, v10, v10 row_ror:8 row_mask:0xf bank_mask:0xf
    v_mov_b32 v11, v10
    s_nop 1
    v_permlane16_swap_b32 v10, v11
    s_nop 0
    v_max_f32 v10, v10, v11
    v_mov_b32 v11, v10
    s_nop 1
    v_permlane32_swap_b32 v10, v11
    s_nop 0
    v_max_f32 v10, v10, v11
    v_sub_f32 v11, v5, v10
    v_mov_b32 v5, v10
    v_mul_f32 v11, s70, v11
    v_exp_f32 v11, v11
    s_nop 1
    v_mul_f32 v6, v6, v11
    v_mul_f32 v7, v7, v11
    v_readlane_b32 s82, v11, 0
    v_readlane_b32 s83, v11, 4
    s_nop 1
    v_mov_b32 v10, s82
    v_mov_b32 v11, s83
    v_cndmask_b32 v10, v10, v11, s[76:77]
    s_nop 7
    v_mul_f32 v56, v56, v10
    v_mul_f32 v57, v57, v10
    v_mul_f32 v58, v58, v10
    v_mul_f32 v59, v59, v10
    v_mul_f32 v60, v60, v10
    v_mul_f32 v61, v61, v10
    v_mul_f32 v62, v62, v10
    v_mul_f32 v63, v63, v10
    s_branch L_back21
L_codeend:
.section .rodata,"a"
.p2align 6
.amdhsa_kernel sequential_preLN__gqa_block_cached__dense_activation_silu__decode_kernel
  .amdhsa_next_free_vgpr 244
  .amdhsa_next_free_sgpr 98
  .amdhsa_accum_offset 180
  .amdhsa_group_segment_fixed_size 0
  .amdhsa_kernarg_size 88
  .amdhsa_user_sgpr_count 2
  .amdhsa_user_sgpr_kernarg_segment_ptr 1
  .amdhsa_system_sgpr_workgroup_id_x 1
.end_amdhsa_kernel
```
